```python
import torch

def _softmax(x, axis=-1):
    return torch.softmax(x, dim=axis)
def _gelu(x):
    return torch.nn.functional.gelu(x, approximate="tanh")
def _silu(x):
    return torch.nn.functional.silu(x)
def _sigmoid(x):
    return torch.sigmoid(x)
def _layernorm(x, axis=-1, eps=1e-5):
    m = x.mean(dim=axis, keepdim=True)
    v = x.var(dim=axis, keepdim=True, unbiased=False)
    return (x - m) / torch.sqrt(v + eps)
def _scatter_add(tgt, idx, src, axis=0):
    return tgt.clone().index_add_(axis, idx, src)
def _segment_sum(src, seg, n):
    out = torch.zeros((n,) + src.shape[1:], dtype=src.dtype)
    return out.index_add_(0, seg, src)
def _pad(x, pw):
    flat = tuple(v for pair in reversed(pw) for v in pair)
    return torch.nn.functional.pad(x, flat)

kernel_name = 'standalone__deep_cross_pnn__recsys'

def setup_inputs():

    _w = (lambda a: (lambda t: t.to(torch.bfloat16) if t.is_floating_point() else t)(torch.as_tensor(a)))
    B, F, D, V = 4096, 100, 64, min(100000, 100000)
    H = 4 * D
    return {
        "idx": _w((lambda lo, hi, *s: torch.randint(lo, hi, s))(0, V, B, F).to(torch.int64)),
        "table": _w((lambda *s: torch.randn(*s, dtype=torch.bfloat16) * 1.6)(V, D) * (D ** -0.5)),
        "w_p": _w((lambda *s: torch.randn(*s, dtype=torch.bfloat16) * 0.05)(F * F) * ((F * F) ** -0.5)),
        "w1": _w((lambda *s: torch.randn(*s, dtype=torch.bfloat16) * 1.6)(F * D, H) * ((F * D) ** -0.5)),
        "b1": _w((lambda *s: torch.randn(*s, dtype=torch.bfloat16) * 12.8)(H) * 0.01),
        "w2": _w((lambda *s: torch.randn(*s, dtype=torch.bfloat16) * 0.05)(H) * (H ** -0.5)),
        "b2": _w((lambda *s: torch.randn(*s, dtype=torch.bfloat16) * 3.2)(1) * 0.01),
    }

def reference(idx, table, w_p, w1, b1, w2, b2):
    emb = table[idx]
    B = emb.shape[0]; F = emb.shape[1]; D = emb.shape[2]
    ip = torch.einsum('bid,bjd->bij', emb, emb)
    ip = ip.reshape(B, F * F)
    logit_p = ip @ w_p
    z = emb.reshape(B, F * D)
    h = _gelu(z @ w1 + b1)
    logit_d = h @ w2 + b2
    return logit_p + logit_d
```

```asm
; @launch grid=(256,1,1) block=(256,1,1) lds=163840
.amdgcn_target "amdgcn-amd-amdhsa--gfx950"
.text
.globl standalone__deep_cross_pnn__recsys_kernel
.p2align 8
.type standalone__deep_cross_pnn__recsys_kernel,@function
standalone__deep_cross_pnn__recsys_kernel:
    s_cmp_ge_u32 s2, 256
    s_cbranch_scc1 L_end
    s_load_dwordx2 s[16:17], s[0:1], 0
    s_load_dwordx2 s[24:25], s[0:1], 24
    s_load_dwordx2 s[28:29], s[0:1], 16
    s_load_dwordx2 s[20:21], s[0:1], 8
    s_load_dwordx2 s[32:33], s[0:1], 32
    s_load_dwordx2 s[36:37], s[0:1], 40
    s_load_dwordx2 s[52:53], s[0:1], 48
    s_load_dwordx2 s[44:45], s[0:1], 56
    s_load_dwordx2 s[48:49], s[0:1], 64
    s_load_dwordx2 s[40:41], s[0:1], 72
    v_lshrrev_b32 v1, 6, v0
    v_and_b32 v240, 63, v0
    v_readfirstlane_b32 s56, v1
    s_lshr_b32 s62, s2, 3
    s_lshr_b32 s63, s62, 3
    s_and_b32 s58, s62, 7
    s_getpc_b64 s[12:13]
L_pc0:
    s_lshl2_add_u32 s3, s58, s56
    s_lshl_b32 s3, s3, 9
    s_add_u32 s3, s3, L_pc0+0-L_pc0
    v_lshl_add_u32 v236, v240, 3, s3
    global_load_dwordx2 a[254:255], v236, s[12:13]
    s_and_b32 s3, s2, 7
    s_and_b32 s60, s62, 1
    s_lshr_b32 s59, s58, 1
    s_lshl2_add_u32 s57, s3, s63
    s_lshl2_add_u32 s61, s60, s63
    s_lshl_b32 s61, s61, 2
    s_or_b32 s61, s61, 0x40000
    v_lshrrev_b32 v2, 3, v240
    v_and_b32 v3, 7, v240
    v_mul_u32_u24 v4, 400, v2
    v_xor_b32 v8, v2, v3
    v_lshl_add_u32 v4, v8, 4, v4
    s_mul_i32 s3, s57, 51200
    s_andn2_b32 s62, 1, s59
    s_xor_b32 s62, s62, s56
    s_mul_i32 s62, s62, 12800
    s_cmp_eq_u32 s60, 0
    s_cselect_b32 s14, 6400, 0
    s_cselect_b32 s11, 0, 12800
    s_add_u32 s62, s62, s14
    s_lshl_b32 s74, s59, 3
    s_or_b32 s74, s74, 0x80000
    s_bfe_u32 s75, 0x4c341800, s74
    s_bfe_i32 s78, 0xcfe60118, s74
    v_cmp_le_u32 vcc, 6, v8
    s_add_u32 s74, s59, 24
    v_mov_b32 v5, s75
    v_mov_b32 v6, s74
    v_cndmask_b32 v5, v5, v6, vcc
    v_lshl_add_u32 v4, v5, 2, v4
    s_add_u32 s76, s62, s3
    s_mul_i32 s62, s58, 6400
    s_add_u32 s3, s3, s62
    s_mul_i32 s62, s56, 1600
    s_add_u32 s77, s3, s62
    s_lshl_b32 s68, s56, 12
    v_and_b32 v5, 2, v2
    v_xor_b32 v5, v5, v3
    v_lshlrev_b32 v6, 9, v2
    v_lshl_add_u32 v228, v5, 4, v6
    v_xor_b32 v5, 64, v228
    v_add_u32 v229, 3072, v5
    v_add_u32 v230, 6144, v228
    v_add_u32 v231, 9216, v5
    s_and_b32 s3, s56, 1
    s_lshr_b32 s62, s56, 1
    s_lshl_b32 s69, s3, 13
    s_lshl_b32 s63, s62, 12
    s_add_u32 s69, s69, s63
    s_add_u32 s69, s69, 49152
    s_lshl_b32 s70, s75, 15
    s_lshl_b32 s63, s62, 14
    s_add_u32 s70, s70, s63
    s_lshl_b32 s63, s60, 8
    s_add_u32 s70, s70, s63
    s_lshl_b32 s63, s3, 7
    s_add_u32 s70, s70, s63
    s_lshl_b32 s64, s78, 15
    s_add_u32 s64, s64, s70
    v_lshlrev_b32 v225, 4, v240
    s_mov_b32 s18, 1638400
    s_mov_b32 s19, 0x20000
    s_mov_b32 s26, 3276800
    s_mov_b32 s27, 0x20000
    s_mov_b32 s30, 20000
    s_mov_b32 s31, 0x20000
    s_mov_b32 s22, 12800000
    s_mov_b32 s23, 0x20000
    s_bfe_i32 s74, 0x10020210, s61
    s_add_u32 s74, s74, 0
    s_bfe_i32 s75, 0xf02f2ff0, s61
    s_add_u32 s75, s75, 1
    s_bfe_i32 s78, 0x2ffff02, s61
    s_add_u32 s78, s78, 2
    v_lshrrev_b32 v7, 4, v240
    v_xor_b32 v8, v3, v7
    v_lshlrev_b32 v241, 4, v8
    v_xor_b32 v242, 64, v241
    s_add_u32 s62, s68, 98304
    v_mul_u32_u24 v250, 144, v2
    v_add_u32 v250, s62, v250
    s_waitcnt lgkmcnt(0)
    s_add_u32 m0, s68, 98304
    s_mov_b32 exec_lo, 0xefdfbf7f
    s_mov_b32 exec_hi, 0xfefdfbf7
    buffer_load_dwordx4 v4, s[16:19], s76 offen nt lds
    s_add_u32 m0, s68, 99328
    s_add_u32 s76, s76, 3200
    buffer_load_dwordx4 v4, s[16:19], s76 offen nt lds
    s_add_u32 m0, s68, 100352
    s_add_u32 s76, s76, s11
    s_sub_u32 s76, s76, 9600
    buffer_load_dwordx4 v4, s[16:19], s76 offen nt lds
    s_add_u32 m0, s68, 101376
    s_add_u32 s76, s76, 3200
    buffer_load_dwordx4 v4, s[16:19], s76 offen nt lds
    s_mov_b64 exec, -1
    s_lshl_b32 s72, s74, 15
    s_add_u32 s72, s72, s70
    s_add_u32 m0, s69, 0
    s_nop 0
    buffer_load_dwordx4 v228, s[24:27], s72 offen offset:0 lds
    buffer_load_dwordx4 v229, s[24:27], s72 offen offset:1024 lds
    buffer_load_dwordx4 v230, s[24:27], s72 offen offset:2048 lds
    buffer_load_dwordx4 v231, s[24:27], s72 offen offset:3072 lds
    s_mul_i32 s62, s56, 1600
    s_add_u32 m0, s62, 155648
    s_nop 0
    buffer_load_dwordx4 v225, s[16:19], s77 offen offset:0 nt lds
    buffer_load_dwordx4 v225, s[16:19], s77 offen offset:1024 nt lds
    s_lshl_b32 s72, s75, 15
    s_add_u32 s72, s72, s70
    s_add_u32 m0, s69, 16384
    s_nop 0
    buffer_load_dwordx4 v228, s[24:27], s72 offen offset:0 lds
    buffer_load_dwordx4 v229, s[24:27], s72 offen offset:1024 lds
    buffer_load_dwordx4 v230, s[24:27], s72 offen offset:2048 lds
    buffer_load_dwordx4 v231, s[24:27], s72 offen offset:3072 lds
    s_waitcnt vmcnt(10)
    s_lshl_b32 s10, s74, 2
    v_xor_b32 v254, s10, v250
    ds_read2st64_b32 v[20:21], v254 offset0:0 offset1:4
    ds_read2st64_b32 v[22:23], v254 offset0:8 offset1:12
    s_lshl_b32 s10, s75, 2
    v_xor_b32 v254, s10, v250
    ds_read2st64_b32 v[24:25], v254 offset0:0 offset1:4
    ds_read2st64_b32 v[26:27], v254 offset0:8 offset1:12
    s_lshl_b32 s10, s78, 2
    v_xor_b32 v254, s10, v250
    ds_read2st64_b32 v[128:129], v254 offset0:0 offset1:4
    ds_read2st64_b32 v[130:131], v254 offset0:8 offset1:12
    s_waitcnt lgkmcnt(4)
    s_add_u32 m0, s68, 0
    v_lshl_add_u32 v20, v20, 7, v241
    buffer_load_dwordx4 v20, s[20:23], 0 offen lds
    s_add_u32 m0, s68, 1024
    v_lshl_add_u32 v21, v21, 7, v242
    buffer_load_dwordx4 v21, s[20:23], 0 offen lds
    s_add_u32 m0, s68, 2048
    v_lshl_add_u32 v22, v22, 7, v241
    buffer_load_dwordx4 v22, s[20:23], 0 offen lds
    s_add_u32 m0, s68, 3072
    v_lshl_add_u32 v23, v23, 7, v242
    buffer_load_dwordx4 v23, s[20:23], 0 offen lds
    s_waitcnt lgkmcnt(2)
    s_add_u32 m0, s68, 16384
    v_lshl_add_u32 v24, v24, 7, v241
    buffer_load_dwordx4 v24, s[20:23], 0 offen lds
    s_add_u32 m0, s68, 17408
    v_lshl_add_u32 v25, v25, 7, v242
    buffer_load_dwordx4 v25, s[20:23], 0 offen lds
    s_add_u32 m0, s68, 18432
    v_lshl_add_u32 v26, v26, 7, v241
    buffer_load_dwordx4 v26, s[20:23], 0 offen lds
    s_add_u32 m0, s68, 19456
    v_lshl_add_u32 v27, v27, 7, v242
    buffer_load_dwordx4 v27, s[20:23], 0 offen lds
    s_mov_b32 s46, 8192
    s_mov_b32 s47, 0x20000
    s_mov_b32 s50, 256
    s_mov_b32 s51, 0x20000
    v_lshrrev_b32 v9, 5, v240
    v_bfe_u32 v10, v240, 1, 3
    v_xor_b32 v10, v10, v7
    v_lshlrev_b32 v10, 4, v10
    v_and_b32 v11, 15, v240
    v_lshl_add_u32 v10, v11, 7, v10
    s_lshr_b32 s62, s56, 1
    s_lshl_b32 s62, s62, 13
    v_add_u32 v244, s62, v10
    v_xor_b32 v245, 64, v244
    v_bfe_u32 v12, v240, 2, 2
    v_and_b32 v13, 3, v240
    v_lshl_add_u32 v14, v7, 3, v12
    v_lshlrev_b32 v14, 7, v14
    v_and_b32 v15, 1, v7
    v_lshlrev_b32 v15, 2, v15
    v_lshrrev_b32 v16, 1, v13
    v_xor_b32 v15, v15, v16
    v_and_b32 v16, 2, v12
    v_xor_b32 v15, v15, v16
    v_lshl_add_u32 v14, v15, 4, v14
    v_and_b32 v16, 1, v13
    v_lshl_add_u32 v14, v16, 3, v14
    s_and_b32 s3, s56, 1
    s_lshl_b32 s3, s3, 13
    s_add_u32 s3, s3, 49152
    v_add_u32 v248, s3, v14
    v_xor_b32 v249, 32, v248
    v_xor_b32 v246, 64, v248
    v_xor_b32 v247, 96, v248
    v_lshrrev_b32 v17, 2, v2
    v_and_b32 v18, 3, v2
    v_lshlrev_b32 v18, 2, v18
    v_mul_u32_u24 v19, 96, v17
    s_mul_i32 s62, s56, 1600
    s_add_u32 s62, s62, 155648
    v_add3_u32 v251, v19, v18, s62
    v_add_u32 v152, 800, v251
    v_mul_u32_u24 v19, 400, v17
    s_add_u32 s62, s62, 192
    v_add3_u32 v153, v19, v18, s62
    s_mul_i32 s93, s56, 5120
    s_add_u32 s93, s93, 135168
    v_and_b32 v19, 15, v240
    v_bfe_u32 v32, v240, 1, 3
    v_xor_b32 v32, v32, v7
    v_lshlrev_b32 v32, 4, v32
    v_lshl_add_u32 v32, v19, 7, v32
    v_add_u32 v148, s93, v32
    v_xor_b32 v149, 64, v148
    v_lshrrev_b32 v19, 3, v19
    v_mul_u32_u24 v19, 5120, v19
    v_sub_u32 v150, v148, v19
    v_sub_u32 v151, v149, v19
    s_cmp_eq_u32 s56, 0
    s_cselect_b64 s[80:81], 1, 0
    s_mov_b32 s79, 0xffff0000
    s_mov_b32 s82, 0x11111111
    s_mov_b32 s83, 0x11111111
    s_mov_b32 s4, 0x000f000f
    s_mov_b32 s5, 0x000f000f
    v_mov_b32 v235, 1
    v_add_u32 v154, 98304, v225
    v_mul_u32_u24 v34, 24, v7
    v_and_b32 v33, 2, v7
    v_lshl_add_u32 v34, v33, 1, v34
    v_mul_u32_u24 v35, 24, v12
    v_and_b32 v33, 2, v12
    v_lshl_add_u32 v35, v33, 1, v35
    v_mul_u32_u24 v36, 24, v13
    v_and_b32 v33, 2, v13
    v_lshl_add_u32 v36, v33, 1, v36
    v_add_u32 v37, v34, v12
    v_mul_u32_u24 v37, 200, v37
    v_lshl_add_u32 v37, v36, 1, v37
    v_add_u32 v38, v35, v13
    v_mul_u32_u24 v38, 200, v38
    v_lshl_add_u32 v38, v34, 1, v38
    v_mov_b32 v39, 163832
    v_mov_b32 v40, 0
    v_mov_b32 v41, 0
    ds_write_b64 v39, v[40:41]
    s_lshl_b32 s73, s56, 3
    s_or_b32 s73, s73, 0x80000
    s_bfe_u32 s8, 0x20111000, s73
    s_and_b32 s6, s8, 15
    s_lshr_b32 s7, s8, 4
    s_mul_i32 s8, s6, 800
    s_mul_i32 s9, s7, 800
    s_lshl3_add_u32 s8, s7, s8
    s_lshl3_add_u32 s9, s6, s9
    s_add_u32 s8, s8, 114688
    s_add_u32 s9, s9, 114688
    v_add_u32 v156, s8, v37
    v_add_u32 v158, s9, v38
    s_cmp_eq_u32 s6, s7
    s_cselect_b64 s[84:85], 0, -1
    v_cndmask_b32 v158, v39, v158, s[84:85]
    s_bfe_u32 s8, 0x31302221, s73
    s_and_b32 s6, s8, 15
    s_lshr_b32 s7, s8, 4
    s_mul_i32 s8, s6, 800
    s_mul_i32 s9, s7, 800
    s_lshl3_add_u32 s8, s7, s8
    s_lshl3_add_u32 s9, s6, s9
    s_add_u32 s8, s8, 114688
    s_add_u32 s9, s9, 114688
    v_add_u32 v160, s8, v37
    v_add_u32 v162, s9, v38
    s_cmp_eq_u32 s6, s7
    s_cselect_b64 s[84:85], 0, -1
    v_cndmask_b32 v162, v39, v162, s[84:85]
    s_bfe_u32 s8, 0x41403332, s73
    s_and_b32 s6, s8, 15
    s_lshr_b32 s7, s8, 4
    s_mul_i32 s8, s6, 800
    s_mul_i32 s9, s7, 800
    s_lshl3_add_u32 s8, s7, s8
    s_lshl3_add_u32 s9, s6, s9
    s_add_u32 s8, s8, 114688
    s_add_u32 s9, s9, 114688
    v_add_u32 v164, s8, v37
    v_add_u32 v166, s9, v38
    s_cmp_eq_u32 s6, s7
    s_cselect_b64 s[84:85], 0, -1
    v_cndmask_b32 v166, v39, v166, s[84:85]
    s_bfe_u32 s8, 0x50444342, s73
    s_and_b32 s6, s8, 15
    s_lshr_b32 s7, s8, 4
    s_mul_i32 s8, s6, 800
    s_mul_i32 s9, s7, 800
    s_lshl3_add_u32 s8, s7, s8
    s_lshl3_add_u32 s9, s6, s9
    s_add_u32 s8, s8, 114688
    s_add_u32 s9, s9, 114688
    v_add_u32 v168, s8, v37
    v_add_u32 v170, s9, v38
    s_cmp_eq_u32 s6, s7
    s_cselect_b64 s[84:85], 0, -1
    v_cndmask_b32 v170, v39, v170, s[84:85]
    s_bfe_u32 s8, 0x54535251, s73
    s_and_b32 s6, s8, 15
    s_lshr_b32 s7, s8, 4
    s_mul_i32 s8, s6, 800
    s_mul_i32 s9, s7, 800
    s_lshl3_add_u32 s8, s7, s8
    s_lshl3_add_u32 s9, s6, s9
    s_add_u32 s8, s8, 114688
    s_add_u32 s9, s9, 114688
    v_add_u32 v172, s8, v37
    v_add_u32 v174, s9, v38
    s_bfe_u32 s8, 0xc2c1c055, s73
    s_and_b32 s6, s8, 15
    s_lshr_b32 s7, s8, 4
    s_mul_i32 s8, s6, 800
    s_mul_i32 s9, s7, 800
    s_lshl3_add_u32 s8, s7, s8
    s_lshl3_add_u32 s9, s6, s9
    s_add_u32 s8, s8, 114688
    s_add_u32 s9, s9, 114688
    v_add_u32 v176, s8, v37
    v_add_u32 v178, s9, v38
    s_cmp_eq_u32 s6, s7
    s_cselect_b64 s[84:85], 0, s[4:5]
    s_cselect_b64 s[86:87], -1, s[82:83]
    v_cndmask_b32 v178, v39, v178, s[84:85]
    v_cndmask_b32 v176, v39, v176, s[86:87]
    s_bfe_u32 s8, 0xccc5c4c3, s73
    s_and_b32 s6, s8, 15
    s_lshr_b32 s7, s8, 4
    s_mul_i32 s8, s6, 800
    s_mul_i32 s9, s7, 800
    s_lshl3_add_u32 s8, s7, s8
    s_lshl3_add_u32 s9, s6, s9
    s_add_u32 s8, s8, 114688
    s_add_u32 s9, s9, 114688
    v_add_u32 v180, s8, v37
    v_add_u32 v182, s9, v38
    s_cmp_eq_u32 s6, s7
    s_cselect_b64 s[84:85], 0, s[4:5]
    s_cselect_b64 s[86:87], 0x1111, s[82:83]
    v_cndmask_b32 v182, v39, v182, s[84:85]
    v_cndmask_b32 v180, v39, v180, s[86:87]
    v_lshl_add_u32 v19, v7, 2, v13
    v_lshlrev_b32 v19, 4, v19
    s_lshl_b32 s3, s60, 15
    v_lshl_add_u32 v224, v12, 13, v19
    v_add_u32 v224, s3, v224
    v_xor_b32 v233, 0x8000, v224
    s_and_b32 s3, s56, 1
    s_lshl_b32 s3, s3, 8
    s_add_u32 s3, s3, 106496
    v_lshl_add_u32 v252, v12, 10, v19
    v_add_u32 v252, s3, v252
    s_lshl_b32 s3, s56, 10
    s_add_u32 s3, s3, 106496
    v_and_b32 v253, 31, v240
    v_lshlrev_b32 v253, 4, v253
    v_add_u32 v253, s3, v253
    s_cmp_eq_u32 s60, 0
    s_cselect_b32 s14, 0, -1
    s_cselect_b32 s15, -1, 0
    s_lshr_b32 s3, s58, 2
    s_lshr_b32 s62, s56, 1
    s_cmp_eq_u32 s3, s62
    s_cselect_b64 s[12:13], 0, -1
    v_lshlrev_b32 v243, 2, v11
    s_lshr_b32 s62, s56, 1
    s_lshl_b32 s3, s57, 3
    s_lshl2_add_u32 s3, s62, s3
    s_and_b32 s62, s56, 1
    s_lshl1_add_u32 s62, s60, s62
    s_lshl3_add_u32 s63, s59, s62
    s_lshl_b32 s63, s63, 8
    s_lshl2_add_u32 s62, s62, s59
    s_lshl_b32 s88, s3, 15
    s_add_u32 s88, s88, s63
    s_add_u32 s88, s88, 1048576
    s_add_u32 s89, s88, 65536
    s_and_b32 s63, s56, 2
    s_lshl_b32 s63, s63, 11
    s_xor_b32 s88, s88, s63
    s_bitcmp0_b32 s59, 0
    s_cselect_b32 s63, 0x10800, 0
    s_xor_b32 s88, s88, s63
    s_xor_b32 s89, s88, 0x10800
    s_lshl_b32 s95, s3, 7
    s_lshl2_add_u32 s95, s62, s95
    s_add_u32 s95, s95, 16777216
    v_lshlrev_b32 v227, 7, v240
    s_mov_b32 s42, 33554432
    s_mov_b32 s43, 0x20000
    s_lshl3_add_u32 s90, s57, s58
    s_lshl2_add_u32 s90, s90, s56
    s_lshl_b32 s90, s90, 13
    s_add_u32 s90, s90, 1048576
    s_add_u32 s91, s90, 4096
    v_accvgpr_write_b32 a224, 0
    v_accvgpr_write_b32 a225, 0
    v_accvgpr_write_b32 a226, 0
    v_accvgpr_write_b32 a227, 0
    s_lshl3_add_u32 s96, s57, s58
    s_lshl_b32 s96, s96, 7
    s_add_u32 s96, s96, 16777216
    v_bfe_u32 v18, v240, 2, 2
    v_cmp_eq_u32 vcc, v18, v7
    v_and_b32 v18, 1, v240
    v_lshlrev_b32 v18, 4, v18
    v_mov_b32 v19, 0x3f80
    v_lshlrev_b32 v18, v18, v19
    v_cndmask_b32 v18, 0, v18, vcc
    v_and_b32 v19, 2, v240
    v_cmp_eq_u32 vcc, 0, v19
    s_nop 1
    v_cndmask_b32 v19, 0, v18, vcc
    v_cndmask_b32 v18, v18, 0, vcc
    v_accvgpr_write_b32 a228, v19
    v_accvgpr_write_b32 a229, v18
    v_accvgpr_write_b32 a230, 0
    v_accvgpr_write_b32 a231, 0
    s_cmp_eq_u32 s56, 0
    s_cselect_b64 exec, 15, 0
    s_and_b32 s3, s96, 0xffffff80
    buffer_store_dwordx4 a[224:227], v225, s[40:43], s3 offen sc1
    s_mov_b64 exec, -1
    s_mul_i32 s84, s56, 5120
    s_add_u32 s85, s84, 4096
    s_add_u32 m0, s84, 114688
    s_nop 0
    buffer_load_dwordx4 v225, s[28:31], s84 offen offset:0 lds
    buffer_load_dwordx4 v225, s[28:31], s84 offen offset:1024 lds
    buffer_load_dwordx4 v225, s[28:31], s84 offen offset:2048 lds
    buffer_load_dwordx4 v225, s[28:31], s84 offen offset:3072 lds
    s_add_u32 m0, s84, 118784
    s_nop 0
    buffer_load_dwordx4 v225, s[28:31], s85 offen offset:0 lds
    s_mov_b32 s34, 512
    s_mov_b32 s35, 0x20000
    s_mov_b32 s38, 512
    s_mov_b32 s39, 0x20000
    s_mov_b32 s54, 2
    s_mov_b32 s55, 0x20000
    v_bfe_u32 v18, v240, 2, 2
    v_lshlrev_b32 v18, 3, v18
    v_lshl_add_u32 v232, v7, 7, v18
    buffer_load_dwordx2 v[200:201], v232, s[32:35], 0 offen offset:0
    buffer_load_dwordx2 v[202:203], v232, s[32:35], 0 offen offset:32
    buffer_load_dwordx2 v[204:205], v232, s[32:35], 0 offen offset:64
    buffer_load_dwordx2 v[206:207], v232, s[32:35], 0 offen offset:96
    buffer_load_dwordx2 v[216:217], v232, s[36:39], 0 offen offset:0
    buffer_load_dwordx2 v[218:219], v232, s[36:39], 0 offen offset:32
    buffer_load_dwordx2 v[220:221], v232, s[36:39], 0 offen offset:64
    buffer_load_dwordx2 v[222:223], v232, s[36:39], 0 offen offset:96
    buffer_load_ushort v226, off, s[52:55], 0
    s_waitcnt vmcnt(27)
    ds_read2_b32 v[144:145], v251 offset0:0 offset1:52
    s_waitcnt vmcnt(19)
    s_barrier
    ds_read_b128 v[64:67], v244 offset:0
    ds_read_b64_tr_b16 v[80:81], v248 offset:0
    ds_read_b64_tr_b16 v[82:83], v248 offset:512
    ds_read_b128 v[68:71], v244 offset:2048
    ds_read_b64_tr_b16 v[84:85], v249 offset:0
    ds_read_b64_tr_b16 v[86:87], v249 offset:512
    ds_read_b128 v[72:75], v244 offset:4096
    ds_read_b64_tr_b16 v[88:89], v246 offset:0
    ds_read_b64_tr_b16 v[90:91], v246 offset:512
    ds_read_b128 v[76:79], v244 offset:6144
    ds_read_b64_tr_b16 v[92:93], v247 offset:0
    s_waitcnt lgkmcnt(10)
    ds_read_b64_tr_b16 v[94:95], v247 offset:512
    s_waitcnt lgkmcnt(6)
    v_mfma_f32_16x16x32_bf16 v[0:3], v[80:83], v[64:67], 0
    s_bfe_i32 s92, 0x2ff0f02f, s61
    s_add_u32 s92, s92, 3
    v_mfma_f32_16x16x32_bf16 v[4:7], v[84:87], v[64:67], 0
    ds_read2_b32 v[146:147], v251 offset0:100 offset1:152
    v_mfma_f32_16x16x32_bf16 v[16:19], v[80:83], v[68:71], 0
    ds_read_b128 v[96:99], v245 offset:0
    ds_read_b64_tr_b16 v[112:113], v248 offset:4096
    s_lshl_b32 s72, s78, 15
    s_add_u32 s72, s72, s70
    v_mfma_f32_16x16x32_bf16 v[20:23], v[84:87], v[68:71], 0
    s_add_u32 m0, s69, 32768
    s_nop 0
    buffer_load_dwordx4 v228, s[24:27], s72 offen offset:0 lds
    buffer_load_dwordx4 v229, s[24:27], s72 offen offset:1024 lds
    s_waitcnt lgkmcnt(3)
    v_mfma_f32_16x16x32_bf16 v[8:11], v[88:91], v[64:67], 0
    ds_read_b64_tr_b16 v[114:115], v248 offset:4608
    ds_read_b128 v[100:103], v245 offset:2048
    v_mfma_f32_16x16x32_bf16 v[24:27], v[88:91], v[68:71], 0
    buffer_load_dwordx4 v230, s[24:27], s72 offen offset:2048 lds
    v_mfma_f32_16x16x32_bf16 v[32:35], v[80:83], v[72:75], 0
    ds_read_b64_tr_b16 v[116:117], v249 offset:4096
    ds_read_b64_tr_b16 v[118:119], v249 offset:4608
    buffer_load_dwordx4 v231, s[24:27], s72 offen offset:3072 lds
    v_mfma_f32_16x16x32_bf16 v[36:39], v[84:87], v[72:75], 0
    s_add_u32 m0, s68, 32768
    v_lshl_add_u32 v128, v128, 7, v241
    buffer_load_dwordx4 v128, s[20:23], 0 offen lds
    v_mfma_f32_16x16x32_bf16 v[40:43], v[88:91], v[72:75], 0
    ds_read_b128 v[104:107], v245 offset:4096
    ds_read_b64_tr_b16 v[120:121], v246 offset:4096
    s_add_u32 m0, s68, 33792
    v_mfma_f32_16x16x32_bf16 v[12:15], v[92:95], v[64:67], 0
    v_lshl_add_u32 v129, v129, 7, v242
    buffer_load_dwordx4 v129, s[20:23], 0 offen lds
    v_mfma_f32_16x16x32_bf16 v[28:31], v[92:95], v[68:71], 0
    ds_read_b64_tr_b16 v[122:123], v246 offset:4608
    ds_read_b128 v[108:111], v245 offset:6144
    s_add_u32 m0, s68, 34816
    v_lshl_add_u32 v130, v130, 7, v241
    v_mfma_f32_16x16x32_bf16 v[44:47], v[92:95], v[72:75], 0
    buffer_load_dwordx4 v130, s[20:23], 0 offen lds
    s_add_u32 m0, s68, 35840
    v_lshl_add_u32 v131, v131, 7, v242
    buffer_load_dwordx4 v131, s[20:23], 0 offen lds
    v_mfma_f32_16x16x32_bf16 v[48:51], v[80:83], v[76:79], 0
    ds_read_b64_tr_b16 v[124:125], v247 offset:4096
    ds_read_b64_tr_b16 v[126:127], v247 offset:4608
    s_add_u32 m0, s93, 0
    v_mfma_f32_16x16x32_bf16 v[52:55], v[84:87], v[76:79], 0
    v_lshl_add_u32 v144, v144, 7, v241
    buffer_load_dwordx4 v144, s[20:23], 0 offen lds
    v_mfma_f32_16x16x32_bf16 v[56:59], v[88:91], v[76:79], 0
    s_add_u32 m0, s93, 1024
    v_lshl_add_u32 v145, v145, 7, v242
    v_mfma_f32_16x16x32_bf16 v[60:63], v[92:95], v[76:79], 0
    buffer_load_dwordx4 v145, s[20:23], 0 offen lds
    s_waitcnt lgkmcnt(0)
    s_waitcnt vmcnt(19)
    s_barrier
    v_mfma_f32_16x16x32_bf16 v[0:3], v[112:115], v[96:99], v[0:3]
    s_lshl_b32 s10, s92, 2
    v_xor_b32 v254, s10, v250
    ds_read2st64_b32 v[188:189], v254 offset0:0 offset1:4
    ds_read2st64_b32 v[190:191], v254 offset0:8 offset1:12
    v_mfma_f32_16x16x32_bf16 v[4:7], v[116:119], v[96:99], v[4:7]
    s_add_u32 m0, s93, 2048
    v_lshl_add_u32 v146, v146, 7, v241
    buffer_load_dwordx4 v146, s[20:23], 0 offen lds
    v_mfma_f32_16x16x32_bf16 v[16:19], v[112:115], v[100:103], v[16:19]
    ds_read_b128 v[64:67], v244 offset:16384
    ds_read_b64_tr_b16 v[80:81], v248 offset:16384
    s_lshl_b32 s72, s92, 15
    v_mfma_f32_16x16x32_bf16 v[20:23], v[116:119], v[100:103], v[20:23]
    s_add_u32 s72, s72, s70
    s_add_u32 m0, s69, 0
    s_nop 0
    buffer_load_dwordx4 v228, s[24:27], s72 offen offset:0 lds
    v_mfma_f32_16x16x32_bf16 v[8:11], v[120:123], v[96:99], v[8:11]
    ds_read_b64_tr_b16 v[82:83], v248 offset:16896
    v_mfma_f32_16x16x32_bf16 v[24:27], v[120:123], v[100:103], v[24:27]
    ds_read_b128 v[68:71], v244 offset:18432
    v_mfma_f32_16x16x32_bf16 v[32:35], v[112:115], v[104:107], v[32:35]
    ds_read_b64_tr_b16 v[84:85], v249 offset:16384
    ds_read_b64_tr_b16 v[86:87], v249 offset:16896
    v_mfma_f32_16x16x32_bf16 v[36:39], v[116:119], v[104:107], v[36:39]
    buffer_load_dwordx4 v229, s[24:27], s72 offen offset:1024 lds
    v_mfma_f32_16x16x32_bf16 v[40:43], v[120:123], v[104:107], v[40:43]
    ds_read_b128 v[72:75], v244 offset:20480
    ds_read_b64_tr_b16 v[88:89], v246 offset:16384
    v_mfma_f32_16x16x32_bf16 v[12:15], v[124:127], v[96:99], v[12:15]
    buffer_load_dwordx4 v230, s[24:27], s72 offen offset:2048 lds
    v_mfma_f32_16x16x32_bf16 v[28:31], v[124:127], v[100:103], v[28:31]
    ds_read_b64_tr_b16 v[90:91], v246 offset:16896
    v_mfma_f32_16x16x32_bf16 v[44:47], v[124:127], v[104:107], v[44:47]
    ds_read_b128 v[76:79], v244 offset:22528
    v_mfma_f32_16x16x32_bf16 v[48:51], v[112:115], v[108:111], v[48:51]
    ds_read_b64_tr_b16 v[92:93], v247 offset:16384
    ds_read_b64_tr_b16 v[94:95], v247 offset:16896
    v_mfma_f32_16x16x32_bf16 v[52:55], v[116:119], v[108:111], v[52:55]
    buffer_load_dwordx4 v231, s[24:27], s72 offen offset:3072 lds
    v_mfma_f32_16x16x32_bf16 v[56:59], v[120:123], v[108:111], v[56:59]
    v_mfma_f32_16x16x32_bf16 v[60:63], v[124:127], v[108:111], v[60:63]
    s_waitcnt lgkmcnt(6)
    v_mfma_f32_16x16x32_bf16 v[0:3], v[80:83], v[64:67], v[0:3]
    s_bfe_i32 s71, 0xff0202ff, s61
    s_add_u32 s71, s71, 4
    v_mfma_f32_16x16x32_bf16 v[4:7], v[84:87], v[64:67], v[4:7]
    ds_read2_b32 v[144:145], v152 offset0:0 offset1:52
    ds_read_b64_tr_b16 v[156:157], v156
    v_mfma_f32_16x16x32_bf16 v[16:19], v[80:83], v[68:71], v[16:19]
    ds_read_b128 v[96:99], v245 offset:16384
    ds_read_b64_tr_b16 v[112:113], v248 offset:20480
    s_add_u32 m0, s93, 3072
    v_mfma_f32_16x16x32_bf16 v[20:23], v[84:87], v[68:71], v[20:23]
    v_lshl_add_u32 v147, v147, 7, v242
    buffer_load_dwordx4 v147, s[20:23], 0 offen lds
    ds_read_b64 v[158:159], v158
    s_waitcnt lgkmcnt(5)
    v_mfma_f32_16x16x32_bf16 v[8:11], v[88:91], v[64:67], v[8:11]
    ds_read_b64_tr_b16 v[114:115], v248 offset:20992
    ds_read_b128 v[100:103], v245 offset:18432
    s_add_u32 m0, s68, 0
    v_mfma_f32_16x16x32_bf16 v[24:27], v[88:91], v[68:71], v[24:27]
    v_lshl_add_u32 v188, v188, 7, v241
    buffer_load_dwordx4 v188, s[20:23], 0 offen lds
    ds_read_b64_tr_b16 v[160:161], v160
    v_mfma_f32_16x16x32_bf16 v[32:35], v[80:83], v[72:75], v[32:35]
    ds_read_b64_tr_b16 v[116:117], v249 offset:20480
    ds_read_b64_tr_b16 v[118:119], v249 offset:20992
    s_add_u32 m0, s68, 1024
    v_mfma_f32_16x16x32_bf16 v[36:39], v[84:87], v[72:75], v[36:39]
    v_lshl_add_u32 v189, v189, 7, v242
    buffer_load_dwordx4 v189, s[20:23], 0 offen lds
    ds_read_b64 v[162:163], v162
    v_mfma_f32_16x16x32_bf16 v[40:43], v[88:91], v[72:75], v[40:43]
    ds_read_b128 v[104:107], v245 offset:20480
    ds_read_b64_tr_b16 v[120:121], v246 offset:20480
    v_mfma_f32_16x16x32_bf16 v[12:15], v[92:95], v[64:67], v[12:15]
    ds_read_b64_tr_b16 v[164:165], v164
    v_mfma_f32_16x16x32_bf16 v[28:31], v[92:95], v[68:71], v[28:31]
    ds_read_b64_tr_b16 v[122:123], v246 offset:20992
    s_waitcnt lgkmcnt(10)
    ds_read_b128 v[108:111], v245 offset:22528
    s_add_u32 m0, s68, 2048
    v_mfma_f32_16x16x32_bf16 v[44:47], v[92:95], v[72:75], v[44:47]
    v_lshl_add_u32 v190, v190, 7, v241
    buffer_load_dwordx4 v190, s[20:23], 0 offen lds
    ds_read_b64 v[166:167], v166
    v_mfma_f32_16x16x32_bf16 v[48:51], v[80:83], v[76:79], v[48:51]
    ds_read_b64_tr_b16 v[124:125], v247 offset:20480
    ds_read_b64_tr_b16 v[126:127], v247 offset:20992
    s_add_u32 m0, s68, 3072
    v_mfma_f32_16x16x32_bf16 v[52:55], v[84:87], v[76:79], v[52:55]
    v_lshl_add_u32 v191, v191, 7, v242
    buffer_load_dwordx4 v191, s[20:23], 0 offen lds
    ds_read_b64_tr_b16 v[168:169], v168
    v_mfma_f32_16x16x32_bf16 v[56:59], v[88:91], v[76:79], v[56:59]
    s_waitcnt lgkmcnt(10)
    ds_read_b64 v[170:171], v170
    v_mfma_f32_16x16x32_bf16 v[60:63], v[92:95], v[76:79], v[60:63]
    s_waitcnt lgkmcnt(0)
    s_waitcnt vmcnt(10)
    s_barrier
    v_mfma_f32_16x16x32_bf16 v[0:3], v[112:115], v[96:99], v[0:3]
    ds_read_b128 a[0:3], v148 offset:0
    ds_read_b128 a[4:7], v149 offset:0
    s_lshl_b32 s10, s71, 2
    v_xor_b32 v254, s10, v250
    ds_read2st64_b32 v[188:189], v254 offset0:0 offset1:4
    ds_read2st64_b32 v[190:191], v254 offset0:8 offset1:12
    v_mfma_f32_16x16x32_bf16 v[4:7], v[116:119], v[96:99], v[4:7]
    s_add_u32 m0, s93, 4096
    v_lshl_add_u32 v144, v144, 7, v241
    buffer_load_dwordx4 v144, s[20:23], 0 offen lds
    v_lshlrev_b32 v184, 16, v158
    v_and_b32 v185, s79, v158
    v_lshlrev_b32 v186, 16, v159
    v_mfma_f32_16x16x32_bf16 v[16:19], v[112:115], v[100:103], v[16:19]
    ds_read_b128 v[64:67], v244 offset:32768
    ds_read_b64_tr_b16 v[80:81], v248 offset:32768
    s_lshl_b32 s72, s71, 15
    s_add_u32 s72, s72, s70
    s_add_u32 m0, s69, 16384
    v_mfma_f32_16x16x32_bf16 v[20:23], v[116:119], v[100:103], v[20:23]
    buffer_load_dwordx4 v228, s[24:27], s72 offen offset:0 lds
    v_and_b32 v187, s79, v159
    v_lshlrev_b32 v158, 16, v157
    v_and_b32 v159, s79, v157
    v_mfma_f32_16x16x32_bf16 v[8:11], v[120:123], v[96:99], v[8:11]
    ds_read_b64_tr_b16 v[82:83], v248 offset:33280
    ds_read_b128 v[68:71], v244 offset:34816
    buffer_load_dwordx4 v229, s[24:27], s72 offen offset:1024 lds
    v_mfma_f32_16x16x32_bf16 v[24:27], v[120:123], v[100:103], v[24:27]
    v_and_b32 v157, s79, v156
    v_lshlrev_b32 v156, 16, v156
    v_add_f32 v156, v156, v184
    v_mfma_f32_16x16x32_bf16 v[32:35], v[112:115], v[104:107], v[32:35]
    ds_read_b64_tr_b16 v[84:85], v249 offset:32768
    ds_read_b64_tr_b16 v[86:87], v249 offset:33280
    v_add_f32 v157, v157, v185
    v_mfma_f32_16x16x32_bf16 v[36:39], v[116:119], v[104:107], v[36:39]
    v_add_f32 v158, v158, v186
    v_add_f32 v159, v159, v187
    v_mfma_f32_16x16x32_bf16 v[40:43], v[120:123], v[104:107], v[40:43]
    ds_read_b128 v[72:75], v244 offset:36864
    ds_read_b64_tr_b16 v[88:89], v246 offset:32768
    buffer_load_dwordx4 v230, s[24:27], s72 offen offset:2048 lds
    v_mfma_f32_16x16x32_bf16 v[12:15], v[124:127], v[96:99], v[12:15]
    v_lshlrev_b32 v184, 16, v162
    v_and_b32 v185, s79, v162
    v_lshlrev_b32 v186, 16, v163
    v_mfma_f32_16x16x32_bf16 v[28:31], v[124:127], v[100:103], v[28:31]
    ds_read_b64_tr_b16 v[90:91], v246 offset:33280
    ds_read_b128 v[76:79], v244 offset:38912
    buffer_load_dwordx4 v231, s[24:27], s72 offen offset:3072 lds
    v_mfma_f32_16x16x32_bf16 v[44:47], v[124:127], v[104:107], v[44:47]
    v_and_b32 v187, s79, v163
    v_lshlrev_b32 v162, 16, v161
    v_and_b32 v163, s79, v161
    v_mfma_f32_16x16x32_bf16 v[48:51], v[112:115], v[108:111], v[48:51]
    ds_read_b64_tr_b16 v[92:93], v247 offset:32768
    s_waitcnt lgkmcnt(10)
    ds_read_b64_tr_b16 v[94:95], v247 offset:33280
    s_getpc_b64 s[62:63]
L_pc1:
    s_lshl2_add_u32 s3, s58, s56
    s_lshl_b32 s3, s3, 9
    v_mfma_f32_16x16x32_bf16 v[52:55], v[116:119], v[108:111], v[52:55]
    s_add_u32 s3, s3, L_end-16384-L_pc1
    v_lshl_add_u32 v236, v240, 3, s3
    global_load_dwordx2 a[254:255], v236, s[62:63]
    v_and_b32 v161, s79, v160
    v_lshlrev_b32 v160, 16, v160
    v_add_f32 v160, v160, v184
    v_mfma_f32_16x16x32_bf16 v[56:59], v[120:123], v[108:111], v[56:59]
    v_add_f32 v161, v161, v185
    v_add_f32 v162, v162, v186
    v_mfma_f32_16x16x32_bf16 v[60:63], v[124:127], v[108:111], v[60:63]
    v_add_f32 v163, v163, v187
    s_waitcnt lgkmcnt(6)
    v_mfma_f32_16x16x32_bf16 v[0:3], v[80:83], v[64:67], v[0:3]
    s_bfe_i32 s92, 0xf02f2ff0, s61
    s_add_u32 s92, s92, 5
    v_mfma_f32_16x16x32_bf16 v[4:7], v[84:87], v[64:67], v[4:7]
    ds_read2_b32 v[146:147], v152 offset0:100 offset1:152
    ds_read_b64_tr_b16 v[172:173], v172
    v_mfma_f32_16x16x32_bf16 v[16:19], v[80:83], v[68:71], v[16:19]
    ds_read_b128 v[96:99], v245 offset:32768
    ds_read_b64_tr_b16 v[112:113], v248 offset:36864
    s_add_u32 m0, s93, 0
    v_mfma_f32_16x16x32_bf16 v[20:23], v[84:87], v[68:71], v[20:23]
    v_lshl_add_u32 v145, v145, 7, v242
    buffer_load_dwordx4 v145, s[20:23], 0 offen lds
    ds_read_b64 v[174:175], v174
    s_waitcnt lgkmcnt(5)
    v_mfma_f32_16x16x32_bf16 v[8:11], v[88:91], v[64:67], v[8:11]
    ds_read_b64_tr_b16 v[114:115], v248 offset:37376
    ds_read_b128 v[100:103], v245 offset:34816
    s_add_u32 m0, s68, 16384
    v_mfma_f32_16x16x32_bf16 v[24:27], v[88:91], v[68:71], v[24:27]
    v_lshl_add_u32 v188, v188, 7, v241
    buffer_load_dwordx4 v188, s[20:23], 0 offen lds
    ds_read_b64_tr_b16 v[176:177], v176
    v_mfma_f32_16x16x32_bf16 v[32:35], v[80:83], v[72:75], v[32:35]
    ds_read_b64_tr_b16 v[116:117], v249 offset:36864
    ds_read_b64_tr_b16 v[118:119], v249 offset:37376
    s_add_u32 m0, s68, 17408
    v_mfma_f32_16x16x32_bf16 v[36:39], v[84:87], v[72:75], v[36:39]
    v_lshl_add_u32 v189, v189, 7, v242
    buffer_load_dwordx4 v189, s[20:23], 0 offen lds
    v_mfma_f32_16x16x32_bf16 v[40:43], v[88:91], v[72:75], v[40:43]
    ds_read_b128 v[104:107], v245 offset:36864
    ds_read_b64_tr_b16 v[120:121], v246 offset:36864
    v_mfma_f32_16x16x32_bf16 v[12:15], v[92:95], v[64:67], v[12:15]
    ds_read_b64 v[178:179], v178
    v_mfma_f32_16x16x32_bf16 v[28:31], v[92:95], v[68:71], v[28:31]
    ds_read_b64_tr_b16 v[122:123], v246 offset:37376
    ds_read_b128 v[108:111], v245 offset:38912
    s_add_u32 m0, s68, 18432
    v_mfma_f32_16x16x32_bf16 v[44:47], v[92:95], v[72:75], v[44:47]
    v_lshl_add_u32 v190, v190, 7, v241
    buffer_load_dwordx4 v190, s[20:23], 0 offen lds
    s_waitcnt lgkmcnt(10)
    ds_read_b64_tr_b16 v[180:181], v180
    v_mfma_f32_16x16x32_bf16 v[48:51], v[80:83], v[76:79], v[48:51]
    ds_read_b64_tr_b16 v[124:125], v247 offset:36864
    ds_read_b64_tr_b16 v[126:127], v247 offset:37376
    s_add_u32 m0, s68, 19456
    v_mfma_f32_16x16x32_bf16 v[52:55], v[84:87], v[76:79], v[52:55]
    v_lshl_add_u32 v191, v191, 7, v242
    buffer_load_dwordx4 v191, s[20:23], 0 offen lds
    ds_read_b64 v[182:183], v182
    v_mfma_f32_16x16x32_bf16 v[56:59], v[88:91], v[76:79], v[56:59]
    v_mfma_f32_16x16x32_bf16 v[60:63], v[92:95], v[76:79], v[60:63]
    s_waitcnt lgkmcnt(0)
    s_waitcnt vmcnt(11)
    s_barrier
    v_mfma_f32_16x16x32_bf16 v[0:3], v[112:115], v[96:99], v[0:3]
    ds_read_b128 a[8:11], v148 offset:2048
    ds_read_b128 a[12:15], v149 offset:2048
    s_lshl_b32 s10, s92, 2
    v_xor_b32 v254, s10, v250
    ds_read2st64_b32 v[188:189], v254 offset0:0 offset1:4
    ds_read2st64_b32 v[190:191], v254 offset0:8 offset1:12
    s_add_u32 m0, s93, 1024
    v_mfma_f32_16x16x32_bf16 v[4:7], v[116:119], v[96:99], v[4:7]
    v_lshl_add_u32 v146, v146, 7, v241
    buffer_load_dwordx4 v146, s[20:23], 0 offen lds
    v_lshlrev_b32 v184, 16, v166
    v_and_b32 v185, s79, v166
    v_lshlrev_b32 v186, 16, v167
    v_and_b32 v187, s79, v167
    v_lshlrev_b32 v166, 16, v165
    v_mfma_f32_16x16x32_bf16 v[16:19], v[112:115], v[100:103], v[16:19]
    ds_read_b128 v[64:67], v244 offset:0
    ds_read_b64_tr_b16 v[80:81], v248 offset:0
    s_lshl_b32 s72, s92, 15
    s_add_u32 s72, s72, s70
    s_add_u32 m0, s69, 32768
    v_mfma_f32_16x16x32_bf16 v[20:23], v[116:119], v[100:103], v[20:23]
    buffer_load_dwordx4 v228, s[24:27], s72 offen offset:0 lds
    v_and_b32 v167, s79, v165
    v_and_b32 v165, s79, v164
    v_lshlrev_b32 v164, 16, v164
    v_add_f32 v164, v164, v184
    v_mfma_f32_16x16x32_bf16 v[8:11], v[120:123], v[96:99], v[8:11]
    ds_read_b64_tr_b16 v[82:83], v248 offset:512
    ds_read_b128 v[68:71], v244 offset:2048
    v_add_f32 v165, v165, v185
    v_add_f32 v166, v166, v186
    v_mfma_f32_16x16x32_bf16 v[24:27], v[120:123], v[100:103], v[24:27]
    v_add_f32 v167, v167, v187
    v_lshlrev_b32 v184, 16, v170
    v_and_b32 v185, s79, v170
    v_mfma_f32_16x16x32_bf16 v[32:35], v[112:115], v[104:107], v[32:35]
    ds_read_b64_tr_b16 v[84:85], v249 offset:0
    ds_read_b64_tr_b16 v[86:87], v249 offset:512
    buffer_load_dwordx4 v229, s[24:27], s72 offen offset:1024 lds
    v_lshlrev_b32 v186, 16, v171
    v_mfma_f32_16x16x32_bf16 v[36:39], v[116:119], v[104:107], v[36:39]
    v_and_b32 v187, s79, v171
    v_lshlrev_b32 v170, 16, v169
    v_and_b32 v171, s79, v169
    v_mfma_f32_16x16x32_bf16 v[40:43], v[120:123], v[104:107], v[40:43]
    ds_read_b128 v[72:75], v244 offset:4096
    ds_read_b64_tr_b16 v[88:89], v246 offset:0
    buffer_load_dwordx4 v230, s[24:27], s72 offen offset:2048 lds
    v_and_b32 v169, s79, v168
    v_mfma_f32_16x16x32_bf16 v[12:15], v[124:127], v[96:99], v[12:15]
    v_lshlrev_b32 v168, 16, v168
    v_add_f32 v168, v168, v184
    v_add_f32 v169, v169, v185
    v_add_f32 v170, v170, v186
    v_mfma_f32_16x16x32_bf16 v[28:31], v[124:127], v[100:103], v[28:31]
    ds_read_b64_tr_b16 v[90:91], v246 offset:512
    ds_read_b128 v[76:79], v244 offset:6144
    v_add_f32 v171, v171, v187
    v_mfma_f32_16x16x32_bf16 v[44:47], v[124:127], v[104:107], v[44:47]
    v_lshlrev_b32 v184, 16, v174
    v_and_b32 v185, s79, v174
    v_lshlrev_b32 v186, 16, v175
    v_mfma_f32_16x16x32_bf16 v[48:51], v[112:115], v[108:111], v[48:51]
    ds_read_b64_tr_b16 v[92:93], v247 offset:0
    s_waitcnt lgkmcnt(10)
    ds_read_b64_tr_b16 v[94:95], v247 offset:512
    buffer_load_dwordx4 v231, s[24:27], s72 offen offset:3072 lds
    v_and_b32 v187, s79, v175
    v_mfma_f32_16x16x32_bf16 v[52:55], v[116:119], v[108:111], v[52:55]
    v_lshlrev_b32 v174, 16, v173
    v_and_b32 v175, s79, v173
    v_and_b32 v173, s79, v172
    v_lshlrev_b32 v172, 16, v172
    v_mfma_f32_16x16x32_bf16 v[56:59], v[120:123], v[108:111], v[56:59]
    v_add_f32 v172, v172, v184
    v_add_f32 v173, v173, v185
    v_mfma_f32_16x16x32_bf16 v[60:63], v[124:127], v[108:111], v[60:63]
    v_add_f32 v174, v174, v186
    v_add_f32 v175, v175, v187
    s_waitcnt lgkmcnt(6)
    v_mfma_f32_16x16x32_bf16 v[0:3], v[80:83], v[64:67], v[0:3]
    s_bfe_i32 s71, 0x2ffff02, s61
    s_add_u32 s71, s71, 6
    v_mfma_f32_16x16x32_bf16 v[4:7], v[84:87], v[64:67], v[4:7]
    ds_read2_b32 v[144:145], v251 offset0:4 offset1:56
    v_mfma_f32_16x16x32_bf16 v[16:19], v[80:83], v[68:71], v[16:19]
    ds_read_b128 v[96:99], v245 offset:0
    ds_read_b64_tr_b16 v[112:113], v248 offset:4096
    s_add_u32 m0, s93, 2048
    v_mfma_f32_16x16x32_bf16 v[20:23], v[84:87], v[68:71], v[20:23]
    v_lshl_add_u32 v147, v147, 7, v242
    buffer_load_dwordx4 v147, s[20:23], 0 offen lds
    s_waitcnt lgkmcnt(3)
    v_mfma_f32_16x16x32_bf16 v[8:11], v[88:91], v[64:67], v[8:11]
    ds_read_b64_tr_b16 v[114:115], v248 offset:4608
    ds_read_b128 v[100:103], v245 offset:2048
    s_add_u32 m0, s68, 32768
    v_mfma_f32_16x16x32_bf16 v[24:27], v[88:91], v[68:71], v[24:27]
    v_lshl_add_u32 v188, v188, 7, v241
    buffer_load_dwordx4 v188, s[20:23], 0 offen lds
    v_mfma_f32_16x16x32_bf16 v[32:35], v[80:83], v[72:75], v[32:35]
    ds_read_b64_tr_b16 v[116:117], v249 offset:4096
    ds_read_b64_tr_b16 v[118:119], v249 offset:4608
    s_add_u32 m0, s68, 33792
    v_mfma_f32_16x16x32_bf16 v[36:39], v[84:87], v[72:75], v[36:39]
    v_lshl_add_u32 v189, v189, 7, v242
    buffer_load_dwordx4 v189, s[20:23], 0 offen lds
    v_mfma_f32_16x16x32_bf16 v[40:43], v[88:91], v[72:75], v[40:43]
    ds_read_b128 v[104:107], v245 offset:4096
    v_mfma_f32_16x16x32_bf16 v[12:15], v[92:95], v[64:67], v[12:15]
    ds_read_b64_tr_b16 v[120:121], v246 offset:4096
    v_mfma_f32_16x16x32_bf16 v[28:31], v[92:95], v[68:71], v[28:31]
    ds_read_b64_tr_b16 v[122:123], v246 offset:4608
    ds_read_b128 v[108:111], v245 offset:6144
    s_add_u32 m0, s68, 34816
    v_mfma_f32_16x16x32_bf16 v[44:47], v[92:95], v[72:75], v[44:47]
    v_lshl_add_u32 v190, v190, 7, v241
    buffer_load_dwordx4 v190, s[20:23], 0 offen lds
    v_mfma_f32_16x16x32_bf16 v[48:51], v[80:83], v[76:79], v[48:51]
    ds_read_b64_tr_b16 v[124:125], v247 offset:4096
    ds_read_b64_tr_b16 v[126:127], v247 offset:4608
    s_add_u32 m0, s68, 35840
    v_mfma_f32_16x16x32_bf16 v[52:55], v[84:87], v[76:79], v[52:55]
    v_lshl_add_u32 v191, v191, 7, v242
    buffer_load_dwordx4 v191, s[20:23], 0 offen lds
    v_mfma_f32_16x16x32_bf16 v[56:59], v[88:91], v[76:79], v[56:59]
    s_lshl_b32 s62, s57, 2
    s_mov_b64 exec, s[80:81]
    buffer_atomic_add v235, off, s[48:51], s62 sc1
    s_mov_b64 exec, -1
    v_mfma_f32_16x16x32_bf16 v[60:63], v[92:95], v[76:79], v[60:63]
    s_waitcnt lgkmcnt(0)
    s_waitcnt vmcnt(11)
    s_barrier
    v_mfma_f32_16x16x32_bf16 v[0:3], v[112:115], v[96:99], v[0:3]
    ds_read_b128 a[16:19], v150 offset:4096
    ds_read_b128 a[20:23], v151 offset:4096
    s_lshl_b32 s10, s71, 2
    v_xor_b32 v254, s10, v250
    ds_read2st64_b32 v[188:189], v254 offset0:0 offset1:4
    ds_read2st64_b32 v[190:191], v254 offset0:8 offset1:12
    s_add_u32 m0, s93, 3072
    v_mfma_f32_16x16x32_bf16 v[4:7], v[116:119], v[96:99], v[4:7]
    v_lshl_add_u32 v144, v144, 7, v241
    buffer_load_dwordx4 v144, s[20:23], 0 offen lds
    v_lshlrev_b32 v184, 16, v178
    v_and_b32 v185, s79, v178
    v_lshlrev_b32 v186, 16, v179
    v_and_b32 v187, s79, v179
    v_mfma_f32_16x16x32_bf16 v[16:19], v[112:115], v[100:103], v[16:19]
    ds_read_b128 v[64:67], v244 offset:16384
    ds_read_b64_tr_b16 v[80:81], v248 offset:16384
    s_lshl_b32 s72, s71, 15
    s_add_u32 s72, s72, s70
    s_add_u32 m0, s69, 0
    v_mfma_f32_16x16x32_bf16 v[20:23], v[116:119], v[100:103], v[20:23]
    buffer_load_dwordx4 v228, s[24:27], s72 offen offset:0 lds
    v_lshlrev_b32 v178, 16, v177
    v_and_b32 v179, s79, v177
    v_and_b32 v177, s79, v176
    v_lshlrev_b32 v176, 16, v176
    v_mfma_f32_16x16x32_bf16 v[8:11], v[120:123], v[96:99], v[8:11]
    ds_read_b64_tr_b16 v[82:83], v248 offset:16896
    ds_read_b128 v[68:71], v244 offset:18432
    v_add_f32 v176, v176, v184
    v_mfma_f32_16x16x32_bf16 v[24:27], v[120:123], v[100:103], v[24:27]
    v_add_f32 v177, v177, v185
    v_add_f32 v178, v178, v186
    v_add_f32 v179, v179, v187
    v_mfma_f32_16x16x32_bf16 v[32:35], v[112:115], v[104:107], v[32:35]
    ds_read_b64_tr_b16 v[84:85], v249 offset:16384
    ds_read_b64_tr_b16 v[86:87], v249 offset:16896
    buffer_load_dwordx4 v229, s[24:27], s72 offen offset:1024 lds
    v_lshlrev_b32 v184, 16, v182
    v_mfma_f32_16x16x32_bf16 v[36:39], v[116:119], v[104:107], v[36:39]
    v_and_b32 v185, s79, v182
    v_lshlrev_b32 v186, 16, v183
    v_and_b32 v187, s79, v183
    v_mfma_f32_16x16x32_bf16 v[40:43], v[120:123], v[104:107], v[40:43]
    ds_read_b128 v[72:75], v244 offset:20480
    ds_read_b64_tr_b16 v[88:89], v246 offset:16384
    buffer_load_dwordx4 v230, s[24:27], s72 offen offset:2048 lds
    v_lshlrev_b32 v182, 16, v181
    v_mfma_f32_16x16x32_bf16 v[12:15], v[124:127], v[96:99], v[12:15]
    v_and_b32 v183, s79, v181
    v_and_b32 v181, s79, v180
    v_lshlrev_b32 v180, 16, v180
    v_mfma_f32_16x16x32_bf16 v[28:31], v[124:127], v[100:103], v[28:31]
    ds_read_b64_tr_b16 v[90:91], v246 offset:16896
    ds_read_b128 v[76:79], v244 offset:22528
    v_add_f32 v180, v180, v184
    v_mfma_f32_16x16x32_bf16 v[44:47], v[124:127], v[104:107], v[44:47]
    v_add_f32 v181, v181, v185
    v_add_f32 v182, v182, v186
    v_add_f32 v183, v183, v187
    v_mfma_f32_16x16x32_bf16 v[48:51], v[112:115], v[108:111], v[48:51]
    ds_read_b64_tr_b16 v[92:93], v247 offset:16384
    s_waitcnt lgkmcnt(10)
    ds_read_b64_tr_b16 v[94:95], v247 offset:16896
    buffer_load_dwordx4 v231, s[24:27], s72 offen offset:3072 lds
    s_lshl_b32 s62, s56, 10
    v_mfma_f32_16x16x32_bf16 v[52:55], v[116:119], v[108:111], v[52:55]
    v_add_u32 v236, s62, v154
    ds_write_b128 v236, v[156:159] offset:16384
    ds_write_b128 v236, v[160:163] offset:20480
    v_mfma_f32_16x16x32_bf16 v[56:59], v[120:123], v[108:111], v[56:59]
    ds_write_b128 v236, v[164:167] offset:24576
    ds_write_b128 v236, v[168:171] offset:28672
    v_mfma_f32_16x16x32_bf16 v[60:63], v[124:127], v[108:111], v[60:63]
    s_waitcnt lgkmcnt(10)
    ds_write_b128 v236, v[172:175] offset:32768
    v_mfma_f32_16x16x32_bf16 v[0:3], v[80:83], v[64:67], v[0:3]
    s_bfe_i32 s92, 0x2ff0f02f, s61
    s_add_u32 s92, s92, 7
    v_mfma_f32_16x16x32_bf16 v[4:7], v[84:87], v[64:67], v[4:7]
    ds_read2_b32 v[146:147], v251 offset0:104 offset1:156
    v_mfma_f32_16x16x32_bf16 v[16:19], v[80:83], v[68:71], v[16:19]
    ds_read_b128 v[96:99], v245 offset:16384
    ds_read_b64_tr_b16 v[112:113], v248 offset:20480
    s_add_u32 m0, s93, 4096
    v_mfma_f32_16x16x32_bf16 v[20:23], v[84:87], v[68:71], v[20:23]
    v_lshl_add_u32 v145, v145, 7, v242
    buffer_load_dwordx4 v145, s[20:23], 0 offen lds
    s_waitcnt lgkmcnt(8)
    v_mfma_f32_16x16x32_bf16 v[8:11], v[88:91], v[64:67], v[8:11]
    ds_read_b64_tr_b16 v[114:115], v248 offset:20992
    ds_read_b128 v[100:103], v245 offset:18432
    s_add_u32 m0, s68, 0
    v_mfma_f32_16x16x32_bf16 v[24:27], v[88:91], v[68:71], v[24:27]
    v_lshl_add_u32 v188, v188, 7, v241
    buffer_load_dwordx4 v188, s[20:23], 0 offen lds
    v_mfma_f32_16x16x32_bf16 v[32:35], v[80:83], v[72:75], v[32:35]
    ds_read_b64_tr_b16 v[116:117], v249 offset:20480
    ds_read_b64_tr_b16 v[118:119], v249 offset:20992
    s_add_u32 m0, s68, 1024
    v_mfma_f32_16x16x32_bf16 v[36:39], v[84:87], v[72:75], v[36:39]
    v_lshl_add_u32 v189, v189, 7, v242
    buffer_load_dwordx4 v189, s[20:23], 0 offen lds
    v_mfma_f32_16x16x32_bf16 v[40:43], v[88:91], v[72:75], v[40:43]
    ds_read_b128 v[104:107], v245 offset:20480
    v_mfma_f32_16x16x32_bf16 v[12:15], v[92:95], v[64:67], v[12:15]
    ds_read_b64_tr_b16 v[120:121], v246 offset:20480
    v_mfma_f32_16x16x32_bf16 v[28:31], v[92:95], v[68:71], v[28:31]
    ds_read_b64_tr_b16 v[122:123], v246 offset:20992
    s_waitcnt lgkmcnt(10)
    ds_read_b128 v[108:111], v245 offset:22528
    s_add_u32 m0, s68, 2048
    v_mfma_f32_16x16x32_bf16 v[44:47], v[92:95], v[72:75], v[44:47]
    v_lshl_add_u32 v190, v190, 7, v241
    buffer_load_dwordx4 v190, s[20:23], 0 offen lds
    v_mfma_f32_16x16x32_bf16 v[48:51], v[80:83], v[76:79], v[48:51]
    ds_read_b64_tr_b16 v[124:125], v247 offset:20480
    ds_read_b64_tr_b16 v[126:127], v247 offset:20992
    s_add_u32 m0, s68, 3072
    v_mfma_f32_16x16x32_bf16 v[52:55], v[84:87], v[76:79], v[52:55]
    v_lshl_add_u32 v191, v191, 7, v242
    buffer_load_dwordx4 v191, s[20:23], 0 offen lds
    v_mfma_f32_16x16x32_bf16 v[56:59], v[88:91], v[76:79], v[56:59]
    v_mfma_f32_16x16x32_bf16 v[60:63], v[92:95], v[76:79], v[60:63]
    s_waitcnt lgkmcnt(0)
    s_waitcnt vmcnt(11)
    s_barrier
    v_mfma_f32_16x16x32_bf16 v[0:3], v[112:115], v[96:99], v[0:3]
    ds_read_b128 a[24:27], v148 offset:1024
    ds_read_b128 a[28:31], v149 offset:1024
    s_lshl_b32 s10, s92, 2
    v_xor_b32 v254, s10, v250
    ds_read2st64_b32 v[188:189], v254 offset0:0 offset1:4
    v_mfma_f32_16x16x32_bf16 v[4:7], v[116:119], v[96:99], v[4:7]
    ds_read2st64_b32 v[190:191], v254 offset0:8 offset1:12
    s_add_u32 m0, s93, 0
    v_lshl_add_u32 v146, v146, 7, v241
    buffer_load_dwordx4 v146, s[20:23], 0 offen lds
    v_mfma_f32_16x16x32_bf16 v[16:19], v[112:115], v[100:103], v[16:19]
    ds_read_b128 v[64:67], v244 offset:32768
    ds_read_b64_tr_b16 v[80:81], v248 offset:32768
    s_lshl_b32 s72, s92, 15
    v_mfma_f32_16x16x32_bf16 v[20:23], v[116:119], v[100:103], v[20:23]
    s_add_u32 s72, s72, s70
    s_add_u32 m0, s69, 16384
    s_nop 0
    buffer_load_dwordx4 v228, s[24:27], s72 offen offset:0 lds
    v_mfma_f32_16x16x32_bf16 v[8:11], v[120:123], v[96:99], v[8:11]
    ds_read_b64_tr_b16 v[82:83], v248 offset:33280
    v_mfma_f32_16x16x32_bf16 v[24:27], v[120:123], v[100:103], v[24:27]
    ds_read_b128 v[68:71], v244 offset:34816
    v_mfma_f32_16x16x32_bf16 v[32:35], v[112:115], v[104:107], v[32:35]
    ds_read_b64_tr_b16 v[84:85], v249 offset:32768
    ds_read_b64_tr_b16 v[86:87], v249 offset:33280
    v_mfma_f32_16x16x32_bf16 v[36:39], v[116:119], v[104:107], v[36:39]
    buffer_load_dwordx4 v229, s[24:27], s72 offen offset:1024 lds
    v_mfma_f32_16x16x32_bf16 v[40:43], v[120:123], v[104:107], v[40:43]
    ds_read_b128 v[72:75], v244 offset:36864
    ds_read_b64_tr_b16 v[88:89], v246 offset:32768
    v_mfma_f32_16x16x32_bf16 v[12:15], v[124:127], v[96:99], v[12:15]
    buffer_load_dwordx4 v230, s[24:27], s72 offen offset:2048 lds
    v_mfma_f32_16x16x32_bf16 v[28:31], v[124:127], v[100:103], v[28:31]
    ds_read_b64_tr_b16 v[90:91], v246 offset:33280
    v_mfma_f32_16x16x32_bf16 v[44:47], v[124:127], v[104:107], v[44:47]
    ds_read_b128 v[76:79], v244 offset:38912
    v_mfma_f32_16x16x32_bf16 v[48:51], v[112:115], v[108:111], v[48:51]
    ds_read_b64_tr_b16 v[92:93], v247 offset:32768
    s_waitcnt lgkmcnt(10)
    ds_read_b64_tr_b16 v[94:95], v247 offset:33280
    v_mfma_f32_16x16x32_bf16 v[52:55], v[116:119], v[108:111], v[52:55]
    buffer_load_dwordx4 v231, s[24:27], s72 offen offset:3072 lds
    v_mfma_f32_16x16x32_bf16 v[56:59], v[120:123], v[108:111], v[56:59]
    v_mfma_f32_16x16x32_bf16 v[60:63], v[124:127], v[108:111], v[60:63]
    s_waitcnt lgkmcnt(6)
    v_mfma_f32_16x16x32_bf16 v[0:3], v[80:83], v[64:67], v[0:3]
    s_bfe_i32 s71, 0xff0202ff, s61
    s_add_u32 s71, s71, 8
    v_mfma_f32_16x16x32_bf16 v[4:7], v[84:87], v[64:67], v[4:7]
    ds_read2_b32 v[144:145], v152 offset0:4 offset1:56
    v_mfma_f32_16x16x32_bf16 v[128:131], a[0:3], a[0:3], 0
    v_mfma_f32_16x16x32_bf16 v[16:19], v[80:83], v[68:71], v[16:19]
    ds_read_b128 v[96:99], v245 offset:32768
    ds_read_b64_tr_b16 v[112:113], v248 offset:36864
    s_add_u32 m0, s93, 1024
    v_mfma_f32_16x16x32_bf16 v[20:23], v[84:87], v[68:71], v[20:23]
    v_lshl_add_u32 v147, v147, 7, v242
    buffer_load_dwordx4 v147, s[20:23], 0 offen lds
    v_mfma_f32_16x16x32_bf16 v[132:135], a[8:11], a[8:11], 0
    s_waitcnt lgkmcnt(3)
    v_mfma_f32_16x16x32_bf16 v[8:11], v[88:91], v[64:67], v[8:11]
    ds_read_b64_tr_b16 v[114:115], v248 offset:37376
    ds_read_b128 v[100:103], v245 offset:34816
    s_add_u32 m0, s68, 16384
    v_mfma_f32_16x16x32_bf16 v[24:27], v[88:91], v[68:71], v[24:27]
    v_lshl_add_u32 v188, v188, 7, v241
    buffer_load_dwordx4 v188, s[20:23], 0 offen lds
    v_mfma_f32_16x16x32_bf16 v[136:139], a[16:19], a[16:19], 0
    v_mfma_f32_16x16x32_bf16 v[32:35], v[80:83], v[72:75], v[32:35]
    ds_read_b64_tr_b16 v[116:117], v249 offset:36864
    ds_read_b64_tr_b16 v[118:119], v249 offset:37376
    s_add_u32 m0, s68, 17408
    v_mfma_f32_16x16x32_bf16 v[36:39], v[84:87], v[72:75], v[36:39]
    v_lshl_add_u32 v189, v189, 7, v242
    buffer_load_dwordx4 v189, s[20:23], 0 offen lds
    v_mfma_f32_16x16x32_bf16 v[140:143], a[24:27], a[24:27], 0
    v_mfma_f32_16x16x32_bf16 v[40:43], v[88:91], v[72:75], v[40:43]
    ds_read_b128 v[104:107], v245 offset:36864
    ds_read_b64_tr_b16 v[120:121], v246 offset:36864
    v_mfma_f32_16x16x32_bf16 v[12:15], v[92:95], v[64:67], v[12:15]
    v_mfma_f32_16x16x32_bf16 v[128:131], a[4:7], a[4:7], v[128:131]
    v_mfma_f32_16x16x32_bf16 v[28:31], v[92:95], v[68:71], v[28:31]
    ds_read_b64_tr_b16 v[122:123], v246 offset:37376
    ds_read_b128 v[108:111], v245 offset:38912
    s_add_u32 m0, s68, 18432
    v_mfma_f32_16x16x32_bf16 v[44:47], v[92:95], v[72:75], v[44:47]
    v_lshl_add_u32 v190, v190, 7, v241
    buffer_load_dwordx4 v190, s[20:23], 0 offen lds
    v_mfma_f32_16x16x32_bf16 v[132:135], a[12:15], a[12:15], v[132:135]
    v_mfma_f32_16x16x32_bf16 v[48:51], v[80:83], v[76:79], v[48:51]
    ds_read_b64_tr_b16 v[124:125], v247 offset:36864
    ds_read_b64_tr_b16 v[126:127], v247 offset:37376
    s_add_u32 m0, s68, 19456
    v_mfma_f32_16x16x32_bf16 v[52:55], v[84:87], v[76:79], v[52:55]
    v_lshl_add_u32 v191, v191, 7, v242
    buffer_load_dwordx4 v191, s[20:23], 0 offen lds
    v_mfma_f32_16x16x32_bf16 v[136:139], a[20:23], a[20:23], v[136:139]
    v_mfma_f32_16x16x32_bf16 v[56:59], v[88:91], v[76:79], v[56:59]
    ds_read_b128 v[156:159], v154 offset:16384
    v_mfma_f32_16x16x32_bf16 v[60:63], v[92:95], v[76:79], v[60:63]
    v_mfma_f32_16x16x32_bf16 v[140:143], a[28:31], a[28:31], v[140:143]
    s_waitcnt lgkmcnt(0)
    s_waitcnt vmcnt(10)
    s_barrier
    v_mfma_f32_16x16x32_bf16 v[0:3], v[112:115], v[96:99], v[0:3]
    ds_read_b128 a[32:35], v148 offset:3072
    ds_read_b128 a[36:39], v149 offset:3072
    s_lshl_b32 s10, s71, 2
    v_xor_b32 v254, s10, v250
    ds_read2st64_b32 v[188:189], v254 offset0:0 offset1:4
    ds_read2st64_b32 v[190:191], v254 offset0:8 offset1:12
    v_mfma_f32_16x16x32_bf16 v[4:7], v[116:119], v[96:99], v[4:7]
    s_add_u32 m0, s93, 2048
    v_lshl_add_u32 v144, v144, 7, v241
    buffer_load_dwordx4 v144, s[20:23], 0 offen lds
    v_mul_f32 v160, v128, v156
    v_mul_f32 v161, v132, v156
    v_mfma_f32_16x16x32_bf16 v[16:19], v[112:115], v[100:103], v[16:19]
    ds_read_b128 v[64:67], v244 offset:0
    ds_read_b64_tr_b16 v[80:81], v248 offset:0
    s_lshl_b32 s72, s71, 15
    s_add_u32 s72, s72, s70
    v_mfma_f32_16x16x32_bf16 v[20:23], v[116:119], v[100:103], v[20:23]
    s_add_u32 m0, s69, 32768
    s_nop 0
    buffer_load_dwordx4 v228, s[24:27], s72 offen offset:0 lds
    v_mul_f32 v162, v136, v156
    v_mul_f32 v163, v140, v156
    v_mfma_f32_16x16x32_bf16 v[8:11], v[120:123], v[96:99], v[8:11]
    ds_read_b64_tr_b16 v[82:83], v248 offset:512
    ds_read_b128 v[68:71], v244 offset:2048
    v_mfma_f32_16x16x32_bf16 v[24:27], v[120:123], v[100:103], v[24:27]
    v_fmac_f32 v160, v129, v157
    v_fmac_f32 v161, v133, v157
    v_mfma_f32_16x16x32_bf16 v[32:35], v[112:115], v[104:107], v[32:35]
    ds_read_b64_tr_b16 v[84:85], v249 offset:0
    ds_read_b64_tr_b16 v[86:87], v249 offset:512
    buffer_load_dwordx4 v229, s[24:27], s72 offen offset:1024 lds
    v_mfma_f32_16x16x32_bf16 v[36:39], v[116:119], v[104:107], v[36:39]
    v_fmac_f32 v162, v137, v157
    v_fmac_f32 v163, v141, v157
    v_mfma_f32_16x16x32_bf16 v[40:43], v[120:123], v[104:107], v[40:43]
    ds_read_b128 v[72:75], v244 offset:4096
    ds_read_b64_tr_b16 v[88:89], v246 offset:0
    buffer_load_dwordx4 v230, s[24:27], s72 offen offset:2048 lds
    v_mfma_f32_16x16x32_bf16 v[12:15], v[124:127], v[96:99], v[12:15]
    v_fmac_f32 v160, v130, v158
    v_fmac_f32 v161, v134, v158
    v_mfma_f32_16x16x32_bf16 v[28:31], v[124:127], v[100:103], v[28:31]
    ds_read_b64_tr_b16 v[90:91], v246 offset:512
    ds_read_b128 v[76:79], v244 offset:6144
    v_mfma_f32_16x16x32_bf16 v[44:47], v[124:127], v[104:107], v[44:47]
    v_fmac_f32 v162, v138, v158
    v_fmac_f32 v163, v142, v158
    v_mfma_f32_16x16x32_bf16 v[48:51], v[112:115], v[108:111], v[48:51]
    ds_read_b64_tr_b16 v[92:93], v247 offset:0
    s_waitcnt lgkmcnt(10)
    ds_read_b64_tr_b16 v[94:95], v247 offset:512
    buffer_load_dwordx4 v231, s[24:27], s72 offen offset:3072 lds
    v_mfma_f32_16x16x32_bf16 v[52:55], v[116:119], v[108:111], v[52:55]
    v_fmac_f32 v160, v131, v159
    v_fmac_f32 v161, v135, v159
    v_mfma_f32_16x16x32_bf16 v[56:59], v[120:123], v[108:111], v[56:59]
    v_fmac_f32 v162, v139, v159
    v_mfma_f32_16x16x32_bf16 v[60:63], v[124:127], v[108:111], v[60:63]
    v_fmac_f32 v163, v143, v159
    s_waitcnt lgkmcnt(6)
    v_mfma_f32_16x16x32_bf16 v[0:3], v[80:83], v[64:67], v[0:3]
    s_bfe_i32 s92, 0xf02f2ff0, s61
    s_add_u32 s92, s92, 9
    ds_read2_b32 v[146:147], v152 offset0:104 offset1:156
    v_mfma_f32_16x16x32_bf16 v[4:7], v[84:87], v[64:67], v[4:7]
    v_lshlrev_b32 v192, 16, v200
    v_and_b32 v193, s79, v200
    v_mfma_f32_16x16x32_bf16 v[16:19], v[80:83], v[68:71], v[16:19]
    ds_read_b128 v[96:99], v245 offset:0
    ds_read_b64_tr_b16 v[112:113], v248 offset:4096
    s_add_u32 m0, s93, 3072
    v_lshl_add_u32 v145, v145, 7, v242
    v_mfma_f32_16x16x32_bf16 v[20:23], v[84:87], v[68:71], v[20:23]
    buffer_load_dwordx4 v145, s[20:23], 0 offen lds
    v_lshlrev_b32 v194, 16, v201
    v_and_b32 v195, s79, v201
    s_waitcnt lgkmcnt(3)
    v_mfma_f32_16x16x32_bf16 v[8:11], v[88:91], v[64:67], v[8:11]
    ds_read_b64_tr_b16 v[114:115], v248 offset:4608
    ds_read_b128 v[100:103], v245 offset:2048
    s_add_u32 m0, s68, 32768
    v_lshl_add_u32 v188, v188, 7, v241
    v_mfma_f32_16x16x32_bf16 v[24:27], v[88:91], v[68:71], v[24:27]
    buffer_load_dwordx4 v188, s[20:23], 0 offen lds
    v_lshlrev_b32 v196, 16, v202
    v_and_b32 v197, s79, v202
    v_mfma_f32_16x16x32_bf16 v[32:35], v[80:83], v[72:75], v[32:35]
    ds_read_b64_tr_b16 v[116:117], v249 offset:4096
    ds_read_b64_tr_b16 v[118:119], v249 offset:4608
    s_add_u32 m0, s68, 33792
    v_lshl_add_u32 v189, v189, 7, v242
    v_mfma_f32_16x16x32_bf16 v[36:39], v[84:87], v[72:75], v[36:39]
    buffer_load_dwordx4 v189, s[20:23], 0 offen lds
    v_lshlrev_b32 v198, 16, v203
    v_and_b32 v199, s79, v203
    v_mfma_f32_16x16x32_bf16 v[40:43], v[88:91], v[72:75], v[40:43]
    ds_read_b128 v[104:107], v245 offset:4096
    ds_read_b64_tr_b16 v[120:121], v246 offset:4096
    v_mfma_f32_16x16x32_bf16 v[12:15], v[92:95], v[64:67], v[12:15]
    v_lshlrev_b32 v200, 16, v204
    v_and_b32 v201, s79, v204
    v_mfma_f32_16x16x32_bf16 v[28:31], v[92:95], v[68:71], v[28:31]
    ds_read_b64_tr_b16 v[122:123], v246 offset:4608
    ds_read_b128 v[108:111], v245 offset:6144
    s_add_u32 m0, s68, 34816
    v_lshl_add_u32 v190, v190, 7, v241
    v_mfma_f32_16x16x32_bf16 v[44:47], v[92:95], v[72:75], v[44:47]
    buffer_load_dwordx4 v190, s[20:23], 0 offen lds
    v_lshlrev_b32 v202, 16, v205
    v_and_b32 v203, s79, v205
    v_mfma_f32_16x16x32_bf16 v[48:51], v[80:83], v[76:79], v[48:51]
    ds_read_b64_tr_b16 v[124:125], v247 offset:4096
    ds_read_b64_tr_b16 v[126:127], v247 offset:4608
    s_add_u32 m0, s68, 35840
    v_lshl_add_u32 v191, v191, 7, v242
    v_mfma_f32_16x16x32_bf16 v[52:55], v[84:87], v[76:79], v[52:55]
    buffer_load_dwordx4 v191, s[20:23], 0 offen lds
    v_lshlrev_b32 v204, 16, v206
    v_and_b32 v205, s79, v206
    v_mfma_f32_16x16x32_bf16 v[56:59], v[88:91], v[76:79], v[56:59]
    v_lshlrev_b32 v206, 16, v207
    v_mfma_f32_16x16x32_bf16 v[60:63], v[92:95], v[76:79], v[60:63]
    v_and_b32 v207, s79, v207
    s_waitcnt lgkmcnt(0)
    s_waitcnt vmcnt(10)
    s_barrier
    v_mfma_f32_16x16x32_bf16 v[0:3], v[112:115], v[96:99], v[0:3]
    ds_read_b128 a[40:43], v148 offset:0
    ds_read_b128 a[44:47], v149 offset:0
    s_lshl_b32 s10, s92, 2
    v_xor_b32 v254, s10, v250
    ds_read2st64_b32 v[188:189], v254 offset0:0 offset1:4
    v_mfma_f32_16x16x32_bf16 v[4:7], v[116:119], v[96:99], v[4:7]
    ds_read2st64_b32 v[190:191], v254 offset0:8 offset1:12
    s_add_u32 m0, s93, 4096
    v_lshl_add_u32 v146, v146, 7, v241
    buffer_load_dwordx4 v146, s[20:23], 0 offen lds
    v_mfma_f32_16x16x32_bf16 v[16:19], v[112:115], v[100:103], v[16:19]
    ds_read_b128 v[64:67], v244 offset:16384
    ds_read_b64_tr_b16 v[80:81], v248 offset:16384
    s_lshl_b32 s72, s92, 15
    v_mfma_f32_16x16x32_bf16 v[20:23], v[116:119], v[100:103], v[20:23]
    s_add_u32 s72, s72, s70
    s_add_u32 m0, s69, 0
    s_nop 0
    buffer_load_dwordx4 v228, s[24:27], s72 offen offset:0 lds
    v_mfma_f32_16x16x32_bf16 v[8:11], v[120:123], v[96:99], v[8:11]
    ds_read_b64_tr_b16 v[82:83], v248 offset:16896
    v_mfma_f32_16x16x32_bf16 v[24:27], v[120:123], v[100:103], v[24:27]
    ds_read_b128 v[68:71], v244 offset:18432
    v_mfma_f32_16x16x32_bf16 v[32:35], v[112:115], v[104:107], v[32:35]
    ds_read_b64_tr_b16 v[84:85], v249 offset:16384
    ds_read_b64_tr_b16 v[86:87], v249 offset:16896
    v_mfma_f32_16x16x32_bf16 v[36:39], v[116:119], v[104:107], v[36:39]
    buffer_load_dwordx4 v229, s[24:27], s72 offen offset:1024 lds
    v_mfma_f32_16x16x32_bf16 v[40:43], v[120:123], v[104:107], v[40:43]
    ds_read_b128 v[72:75], v244 offset:20480
    ds_read_b64_tr_b16 v[88:89], v246 offset:16384
    v_mfma_f32_16x16x32_bf16 v[12:15], v[124:127], v[96:99], v[12:15]
    buffer_load_dwordx4 v230, s[24:27], s72 offen offset:2048 lds
    v_mfma_f32_16x16x32_bf16 v[28:31], v[124:127], v[100:103], v[28:31]
    ds_read_b64_tr_b16 v[90:91], v246 offset:16896
    v_mfma_f32_16x16x32_bf16 v[44:47], v[124:127], v[104:107], v[44:47]
    ds_read_b128 v[76:79], v244 offset:22528
    v_mfma_f32_16x16x32_bf16 v[48:51], v[112:115], v[108:111], v[48:51]
    ds_read_b64_tr_b16 v[92:93], v247 offset:16384
    s_waitcnt lgkmcnt(10)
    ds_read_b64_tr_b16 v[94:95], v247 offset:16896
    v_mfma_f32_16x16x32_bf16 v[52:55], v[116:119], v[108:111], v[52:55]
    buffer_load_dwordx4 v231, s[24:27], s72 offen offset:3072 lds
    v_mfma_f32_16x16x32_bf16 v[56:59], v[120:123], v[108:111], v[56:59]
    v_mfma_f32_16x16x32_bf16 v[60:63], v[124:127], v[108:111], v[60:63]
    s_waitcnt lgkmcnt(6)
    v_mfma_f32_16x16x32_bf16 v[0:3], v[80:83], v[64:67], v[0:3]
    s_bfe_i32 s71, 0x2ffff02, s61
    s_add_u32 s71, s71, 10
    ds_read2_b32 v[144:145], v251 offset0:8 offset1:60
    v_mfma_f32_16x16x32_bf16 v[4:7], v[84:87], v[64:67], v[4:7]
    v_lshlrev_b32 v208, 16, v216
    v_and_b32 v209, s79, v216
    v_mfma_f32_16x16x32_bf16 v[16:19], v[80:83], v[68:71], v[16:19]
    ds_read_b128 v[96:99], v245 offset:16384
    ds_read_b64_tr_b16 v[112:113], v248 offset:20480
    s_add_u32 m0, s93, 0
    v_lshl_add_u32 v147, v147, 7, v242
    v_mfma_f32_16x16x32_bf16 v[20:23], v[84:87], v[68:71], v[20:23]
    buffer_load_dwordx4 v147, s[20:23], 0 offen lds
    v_lshlrev_b32 v210, 16, v217
    v_and_b32 v211, s79, v217
    s_waitcnt lgkmcnt(3)
    v_mfma_f32_16x16x32_bf16 v[8:11], v[88:91], v[64:67], v[8:11]
    ds_read_b64_tr_b16 v[114:115], v248 offset:20992
    ds_read_b128 v[100:103], v245 offset:18432
    s_add_u32 m0, s68, 0
    v_lshl_add_u32 v188, v188, 7, v241
    v_mfma_f32_16x16x32_bf16 v[24:27], v[88:91], v[68:71], v[24:27]
    buffer_load_dwordx4 v188, s[20:23], 0 offen lds
    v_lshlrev_b32 v212, 16, v218
    v_and_b32 v213, s79, v218
    v_mfma_f32_16x16x32_bf16 v[32:35], v[80:83], v[72:75], v[32:35]
    ds_read_b64_tr_b16 v[116:117], v249 offset:20480
    ds_read_b64_tr_b16 v[118:119], v249 offset:20992
    s_add_u32 m0, s68, 1024
    v_lshl_add_u32 v189, v189, 7, v242
    v_mfma_f32_16x16x32_bf16 v[36:39], v[84:87], v[72:75], v[36:39]
    buffer_load_dwordx4 v189, s[20:23], 0 offen lds
    v_lshlrev_b32 v214, 16, v219
    v_and_b32 v215, s79, v219
    v_mfma_f32_16x16x32_bf16 v[40:43], v[88:91], v[72:75], v[40:43]
    ds_read_b128 v[104:107], v245 offset:20480
    ds_read_b64_tr_b16 v[120:121], v246 offset:20480
    v_mfma_f32_16x16x32_bf16 v[12:15], v[92:95], v[64:67], v[12:15]
    v_lshlrev_b32 v216, 16, v220
    v_and_b32 v217, s79, v220
    v_mfma_f32_16x16x32_bf16 v[28:31], v[92:95], v[68:71], v[28:31]
    ds_read_b64_tr_b16 v[122:123], v246 offset:20992
    ds_read_b128 v[108:111], v245 offset:22528
    s_add_u32 m0, s68, 2048
    v_lshl_add_u32 v190, v190, 7, v241
    v_mfma_f32_16x16x32_bf16 v[44:47], v[92:95], v[72:75], v[44:47]
    buffer_load_dwordx4 v190, s[20:23], 0 offen lds
    v_lshlrev_b32 v218, 16, v221
    v_and_b32 v219, s79, v221
    v_mfma_f32_16x16x32_bf16 v[48:51], v[80:83], v[76:79], v[48:51]
    ds_read_b64_tr_b16 v[124:125], v247 offset:20480
    ds_read_b64_tr_b16 v[126:127], v247 offset:20992
    s_add_u32 m0, s68, 3072
    v_lshl_add_u32 v191, v191, 7, v242
    v_mfma_f32_16x16x32_bf16 v[52:55], v[84:87], v[76:79], v[52:55]
    buffer_load_dwordx4 v191, s[20:23], 0 offen lds
    v_lshlrev_b32 v220, 16, v222
    v_and_b32 v221, s79, v222
    v_mfma_f32_16x16x32_bf16 v[56:59], v[88:91], v[76:79], v[56:59]
    v_lshlrev_b32 v222, 16, v223
    v_mfma_f32_16x16x32_bf16 v[60:63], v[92:95], v[76:79], v[60:63]
    v_and_b32 v223, s79, v223
    s_waitcnt lgkmcnt(0)
    s_waitcnt vmcnt(10)
    s_barrier
    v_mfma_f32_16x16x32_bf16 v[0:3], v[112:115], v[96:99], v[0:3]
    ds_read_b128 a[48:51], v148 offset:2048
    ds_read_b128 a[52:55], v149 offset:2048
    s_lshl_b32 s10, s71, 2
    v_xor_b32 v254, s10, v250
    ds_read2st64_b32 v[188:189], v254 offset0:0 offset1:4
    v_mfma_f32_16x16x32_bf16 v[4:7], v[116:119], v[96:99], v[4:7]
    ds_read2st64_b32 v[190:191], v254 offset0:8 offset1:12
    s_add_u32 m0, s93, 1024
    v_lshl_add_u32 v144, v144, 7, v241
    buffer_load_dwordx4 v144, s[20:23], 0 offen lds
    v_mfma_f32_16x16x32_bf16 v[16:19], v[112:115], v[100:103], v[16:19]
    ds_read_b128 v[64:67], v244 offset:32768
    ds_read_b64_tr_b16 v[80:81], v248 offset:32768
    s_lshl_b32 s72, s71, 15
    v_mfma_f32_16x16x32_bf16 v[20:23], v[116:119], v[100:103], v[20:23]
    s_add_u32 s72, s72, s70
    s_add_u32 m0, s69, 16384
    s_nop 0
    buffer_load_dwordx4 v228, s[24:27], s72 offen offset:0 lds
    v_mfma_f32_16x16x32_bf16 v[8:11], v[120:123], v[96:99], v[8:11]
    ds_read_b64_tr_b16 v[82:83], v248 offset:33280
    v_mfma_f32_16x16x32_bf16 v[24:27], v[120:123], v[100:103], v[24:27]
    ds_read_b128 v[68:71], v244 offset:34816
    v_mfma_f32_16x16x32_bf16 v[32:35], v[112:115], v[104:107], v[32:35]
    ds_read_b64_tr_b16 v[84:85], v249 offset:32768
    ds_read_b64_tr_b16 v[86:87], v249 offset:33280
    v_mfma_f32_16x16x32_bf16 v[36:39], v[116:119], v[104:107], v[36:39]
    buffer_load_dwordx4 v229, s[24:27], s72 offen offset:1024 lds
    v_mfma_f32_16x16x32_bf16 v[40:43], v[120:123], v[104:107], v[40:43]
    ds_read_b128 v[72:75], v244 offset:36864
    ds_read_b64_tr_b16 v[88:89], v246 offset:32768
    v_mfma_f32_16x16x32_bf16 v[12:15], v[124:127], v[96:99], v[12:15]
    buffer_load_dwordx4 v230, s[24:27], s72 offen offset:2048 lds
    v_mfma_f32_16x16x32_bf16 v[28:31], v[124:127], v[100:103], v[28:31]
    ds_read_b64_tr_b16 v[90:91], v246 offset:33280
    v_mfma_f32_16x16x32_bf16 v[44:47], v[124:127], v[104:107], v[44:47]
    ds_read_b128 v[76:79], v244 offset:38912
    v_mfma_f32_16x16x32_bf16 v[48:51], v[112:115], v[108:111], v[48:51]
    ds_read_b64_tr_b16 v[92:93], v247 offset:32768
    s_waitcnt lgkmcnt(10)
    ds_read_b64_tr_b16 v[94:95], v247 offset:33280
    v_mfma_f32_16x16x32_bf16 v[52:55], v[116:119], v[108:111], v[52:55]
    buffer_load_dwordx4 v231, s[24:27], s72 offen offset:3072 lds
    v_mfma_f32_16x16x32_bf16 v[56:59], v[120:123], v[108:111], v[56:59]
    v_mfma_f32_16x16x32_bf16 v[60:63], v[124:127], v[108:111], v[60:63]
    s_waitcnt lgkmcnt(6)
    v_mfma_f32_16x16x32_bf16 v[0:3], v[80:83], v[64:67], v[0:3]
    s_bfe_i32 s92, 0x2ff0f02f, s61
    s_add_u32 s92, s92, 11
    v_mfma_f32_16x16x32_bf16 v[4:7], v[84:87], v[64:67], v[4:7]
    ds_read2_b32 v[146:147], v251 offset0:108 offset1:160
    v_lshlrev_b32 v226, 16, v226
    v_mfma_f32_16x16x32_bf16 v[16:19], v[80:83], v[68:71], v[16:19]
    ds_read_b128 v[96:99], v245 offset:32768
    ds_read_b64_tr_b16 v[112:113], v248 offset:36864
    s_add_u32 m0, s93, 2048
    v_mfma_f32_16x16x32_bf16 v[20:23], v[84:87], v[68:71], v[20:23]
    v_lshl_add_u32 v145, v145, 7, v242
    buffer_load_dwordx4 v145, s[20:23], 0 offen lds
    s_waitcnt lgkmcnt(3)
    v_mfma_f32_16x16x32_bf16 v[8:11], v[88:91], v[64:67], v[8:11]
    ds_read_b64_tr_b16 v[114:115], v248 offset:37376
    ds_read_b128 v[100:103], v245 offset:34816
    s_add_u32 m0, s68, 16384
    v_mfma_f32_16x16x32_bf16 v[24:27], v[88:91], v[68:71], v[24:27]
    v_lshl_add_u32 v188, v188, 7, v241
    buffer_load_dwordx4 v188, s[20:23], 0 offen lds
    v_mfma_f32_16x16x32_bf16 v[32:35], v[80:83], v[72:75], v[32:35]
    ds_read_b64_tr_b16 v[116:117], v249 offset:36864
    ds_read_b64_tr_b16 v[118:119], v249 offset:37376
    s_add_u32 m0, s68, 17408
    v_mfma_f32_16x16x32_bf16 v[36:39], v[84:87], v[72:75], v[36:39]
    v_lshl_add_u32 v189, v189, 7, v242
    buffer_load_dwordx4 v189, s[20:23], 0 offen lds
    v_mfma_f32_16x16x32_bf16 v[40:43], v[88:91], v[72:75], v[40:43]
    ds_read_b128 v[104:107], v245 offset:36864
    v_mfma_f32_16x16x32_bf16 v[12:15], v[92:95], v[64:67], v[12:15]
    ds_read_b64_tr_b16 v[120:121], v246 offset:36864
    v_mfma_f32_16x16x32_bf16 v[28:31], v[92:95], v[68:71], v[28:31]
    ds_read_b64_tr_b16 v[122:123], v246 offset:37376
    ds_read_b128 v[108:111], v245 offset:38912
    s_add_u32 m0, s68, 18432
    v_mfma_f32_16x16x32_bf16 v[44:47], v[92:95], v[72:75], v[44:47]
    v_lshl_add_u32 v190, v190, 7, v241
    buffer_load_dwordx4 v190, s[20:23], 0 offen lds
    v_mfma_f32_16x16x32_bf16 v[48:51], v[80:83], v[76:79], v[48:51]
    ds_read_b64_tr_b16 v[124:125], v247 offset:36864
    ds_read_b64_tr_b16 v[126:127], v247 offset:37376
    s_add_u32 m0, s68, 19456
    v_mfma_f32_16x16x32_bf16 v[52:55], v[84:87], v[76:79], v[52:55]
    v_lshl_add_u32 v191, v191, 7, v242
    buffer_load_dwordx4 v191, s[20:23], 0 offen lds
    v_mfma_f32_16x16x32_bf16 v[56:59], v[88:91], v[76:79], v[56:59]
    v_mfma_f32_16x16x32_bf16 v[60:63], v[92:95], v[76:79], v[60:63]
    s_waitcnt lgkmcnt(0)
    s_waitcnt vmcnt(10)
    s_barrier
    v_mfma_f32_16x16x32_bf16 v[0:3], v[112:115], v[96:99], v[0:3]
    ds_read_b128 a[56:59], v150 offset:4096
    ds_read_b128 a[60:63], v151 offset:4096
    s_lshl_b32 s10, s92, 2
    v_xor_b32 v254, s10, v250
    ds_read2st64_b32 v[188:189], v254 offset0:0 offset1:4
    v_mfma_f32_16x16x32_bf16 v[4:7], v[116:119], v[96:99], v[4:7]
    ds_read2st64_b32 v[190:191], v254 offset0:8 offset1:12
    s_add_u32 m0, s93, 3072
    v_lshl_add_u32 v146, v146, 7, v241
    buffer_load_dwordx4 v146, s[20:23], 0 offen lds
    v_mfma_f32_16x16x32_bf16 v[16:19], v[112:115], v[100:103], v[16:19]
    ds_read_b128 v[64:67], v244 offset:0
    ds_read_b64_tr_b16 v[80:81], v248 offset:0
    s_lshl_b32 s72, s92, 15
    v_mfma_f32_16x16x32_bf16 v[20:23], v[116:119], v[100:103], v[20:23]
    s_add_u32 s72, s72, s70
    s_add_u32 m0, s69, 32768
    s_nop 0
    buffer_load_dwordx4 v228, s[24:27], s72 offen offset:0 lds
    v_mfma_f32_16x16x32_bf16 v[8:11], v[120:123], v[96:99], v[8:11]
    ds_read_b64_tr_b16 v[82:83], v248 offset:512
    v_mfma_f32_16x16x32_bf16 v[24:27], v[120:123], v[100:103], v[24:27]
    ds_read_b128 v[68:71], v244 offset:2048
    v_mfma_f32_16x16x32_bf16 v[32:35], v[112:115], v[104:107], v[32:35]
    ds_read_b64_tr_b16 v[84:85], v249 offset:0
    ds_read_b64_tr_b16 v[86:87], v249 offset:512
    v_mfma_f32_16x16x32_bf16 v[36:39], v[116:119], v[104:107], v[36:39]
    buffer_load_dwordx4 v229, s[24:27], s72 offen offset:1024 lds
    v_mfma_f32_16x16x32_bf16 v[40:43], v[120:123], v[104:107], v[40:43]
    ds_read_b128 v[72:75], v244 offset:4096
    ds_read_b64_tr_b16 v[88:89], v246 offset:0
    v_mfma_f32_16x16x32_bf16 v[12:15], v[124:127], v[96:99], v[12:15]
    buffer_load_dwordx4 v230, s[24:27], s72 offen offset:2048 lds
    v_mfma_f32_16x16x32_bf16 v[28:31], v[124:127], v[100:103], v[28:31]
    ds_read_b64_tr_b16 v[90:91], v246 offset:512
    v_mfma_f32_16x16x32_bf16 v[44:47], v[124:127], v[104:107], v[44:47]
    ds_read_b128 v[76:79], v244 offset:6144
    v_mfma_f32_16x16x32_bf16 v[48:51], v[112:115], v[108:111], v[48:51]
    ds_read_b64_tr_b16 v[92:93], v247 offset:0
    s_waitcnt lgkmcnt(10)
    ds_read_b64_tr_b16 v[94:95], v247 offset:512
    v_mfma_f32_16x16x32_bf16 v[52:55], v[116:119], v[108:111], v[52:55]
    buffer_load_dwordx4 v231, s[24:27], s72 offen offset:3072 lds
    v_mfma_f32_16x16x32_bf16 v[56:59], v[120:123], v[108:111], v[56:59]
    v_mfma_f32_16x16x32_bf16 v[60:63], v[124:127], v[108:111], v[60:63]
    s_waitcnt lgkmcnt(6)
    v_mfma_f32_16x16x32_bf16 v[0:3], v[80:83], v[64:67], v[0:3]
    s_bfe_i32 s71, 0xff0202ff, s61
    s_add_u32 s71, s71, 12
    v_mfma_f32_16x16x32_bf16 v[4:7], v[84:87], v[64:67], v[4:7]
    ds_read2_b32 v[144:145], v152 offset0:8 offset1:60
    v_mfma_f32_16x16x32_bf16 v[128:131], a[0:3], a[32:35], 0
    v_mfma_f32_16x16x32_bf16 v[16:19], v[80:83], v[68:71], v[16:19]
    ds_read_b128 v[96:99], v245 offset:0
    ds_read_b64_tr_b16 v[112:113], v248 offset:4096
    s_add_u32 m0, s93, 4096
    v_mfma_f32_16x16x32_bf16 v[20:23], v[84:87], v[68:71], v[20:23]
    v_lshl_add_u32 v147, v147, 7, v242
    buffer_load_dwordx4 v147, s[20:23], 0 offen lds
    v_mfma_f32_16x16x32_bf16 v[132:135], a[8:11], a[40:43], 0
    s_waitcnt lgkmcnt(3)
    v_mfma_f32_16x16x32_bf16 v[8:11], v[88:91], v[64:67], v[8:11]
    ds_read_b64_tr_b16 v[114:115], v248 offset:4608
    ds_read_b128 v[100:103], v245 offset:2048
    s_add_u32 m0, s68, 32768
    v_mfma_f32_16x16x32_bf16 v[24:27], v[88:91], v[68:71], v[24:27]
    v_lshl_add_u32 v188, v188, 7, v241
    buffer_load_dwordx4 v188, s[20:23], 0 offen lds
    v_mfma_f32_16x16x32_bf16 v[136:139], a[16:19], a[48:51], 0
    v_mfma_f32_16x16x32_bf16 v[32:35], v[80:83], v[72:75], v[32:35]
    ds_read_b64_tr_b16 v[116:117], v249 offset:4096
    ds_read_b64_tr_b16 v[118:119], v249 offset:4608
    s_add_u32 m0, s68, 33792
    v_mfma_f32_16x16x32_bf16 v[36:39], v[84:87], v[72:75], v[36:39]
    v_lshl_add_u32 v189, v189, 7, v242
    buffer_load_dwordx4 v189, s[20:23], 0 offen lds
    v_mfma_f32_16x16x32_bf16 v[140:143], a[24:27], a[56:59], 0
    v_mfma_f32_16x16x32_bf16 v[40:43], v[88:91], v[72:75], v[40:43]
    ds_read_b128 v[104:107], v245 offset:4096
    ds_read_b64_tr_b16 v[120:121], v246 offset:4096
    v_mfma_f32_16x16x32_bf16 v[12:15], v[92:95], v[64:67], v[12:15]
    v_mfma_f32_16x16x32_bf16 v[128:131], a[4:7], a[36:39], v[128:131]
    v_mfma_f32_16x16x32_bf16 v[28:31], v[92:95], v[68:71], v[28:31]
    ds_read_b64_tr_b16 v[122:123], v246 offset:4608
    ds_read_b128 v[108:111], v245 offset:6144
    s_add_u32 m0, s68, 34816
    v_mfma_f32_16x16x32_bf16 v[44:47], v[92:95], v[72:75], v[44:47]
    v_lshl_add_u32 v190, v190, 7, v241
    buffer_load_dwordx4 v190, s[20:23], 0 offen lds
    v_mfma_f32_16x16x32_bf16 v[132:135], a[12:15], a[44:47], v[132:135]
    v_mfma_f32_16x16x32_bf16 v[48:51], v[80:83], v[76:79], v[48:51]
    ds_read_b64_tr_b16 v[124:125], v247 offset:4096
    ds_read_b64_tr_b16 v[126:127], v247 offset:4608
    s_add_u32 m0, s68, 35840
    v_mfma_f32_16x16x32_bf16 v[52:55], v[84:87], v[76:79], v[52:55]
    v_lshl_add_u32 v191, v191, 7, v242
    buffer_load_dwordx4 v191, s[20:23], 0 offen lds
    v_mfma_f32_16x16x32_bf16 v[136:139], a[20:23], a[52:55], v[136:139]
    v_mfma_f32_16x16x32_bf16 v[56:59], v[88:91], v[76:79], v[56:59]
    ds_read_b128 v[156:159], v154 offset:17408
    v_mfma_f32_16x16x32_bf16 v[60:63], v[92:95], v[76:79], v[60:63]
    v_mfma_f32_16x16x32_bf16 v[140:143], a[28:31], a[60:63], v[140:143]
    s_waitcnt lgkmcnt(0)
    s_waitcnt vmcnt(10)
    s_barrier
    v_mfma_f32_16x16x32_bf16 v[0:3], v[112:115], v[96:99], v[0:3]
    ds_read_b128 a[64:67], v148 offset:1024
    ds_read_b128 a[68:71], v149 offset:1024
    s_lshl_b32 s10, s71, 2
    v_xor_b32 v254, s10, v250
    ds_read2st64_b32 v[188:189], v254 offset0:0 offset1:4
    ds_read2st64_b32 v[190:191], v254 offset0:8 offset1:12
    v_mfma_f32_16x16x32_bf16 v[4:7], v[116:119], v[96:99], v[4:7]
    s_add_u32 m0, s93, 0
    v_lshl_add_u32 v144, v144, 7, v241
    buffer_load_dwordx4 v144, s[20:23], 0 offen lds
    v_fmac_f32 v160, v128, v156
    v_fmac_f32 v161, v132, v156
    v_mfma_f32_16x16x32_bf16 v[16:19], v[112:115], v[100:103], v[16:19]
    ds_read_b128 v[64:67], v244 offset:16384
    ds_read_b64_tr_b16 v[80:81], v248 offset:16384
    s_lshl_b32 s72, s71, 15
    s_add_u32 s72, s72, s70
    v_mfma_f32_16x16x32_bf16 v[20:23], v[116:119], v[100:103], v[20:23]
    s_add_u32 m0, s69, 0
    s_nop 0
    buffer_load_dwordx4 v228, s[24:27], s72 offen offset:0 lds
    v_fmac_f32 v162, v136, v156
    v_fmac_f32 v163, v140, v156
    v_mfma_f32_16x16x32_bf16 v[8:11], v[120:123], v[96:99], v[8:11]
    ds_read_b64_tr_b16 v[82:83], v248 offset:16896
    ds_read_b128 v[68:71], v244 offset:18432
    v_mfma_f32_16x16x32_bf16 v[24:27], v[120:123], v[100:103], v[24:27]
    v_fmac_f32 v160, v129, v157
    v_fmac_f32 v161, v133, v157
    v_mfma_f32_16x16x32_bf16 v[32:35], v[112:115], v[104:107], v[32:35]
    ds_read_b64_tr_b16 v[84:85], v249 offset:16384
    ds_read_b64_tr_b16 v[86:87], v249 offset:16896
    buffer_load_dwordx4 v229, s[24:27], s72 offen offset:1024 lds
    v_mfma_f32_16x16x32_bf16 v[36:39], v[116:119], v[104:107], v[36:39]
    v_fmac_f32 v162, v137, v157
    v_fmac_f32 v163, v141, v157
    v_mfma_f32_16x16x32_bf16 v[40:43], v[120:123], v[104:107], v[40:43]
    ds_read_b128 v[72:75], v244 offset:20480
    ds_read_b64_tr_b16 v[88:89], v246 offset:16384
    buffer_load_dwordx4 v230, s[24:27], s72 offen offset:2048 lds
    v_mfma_f32_16x16x32_bf16 v[12:15], v[124:127], v[96:99], v[12:15]
    v_fmac_f32 v160, v130, v158
    v_fmac_f32 v161, v134, v158
    v_mfma_f32_16x16x32_bf16 v[28:31], v[124:127], v[100:103], v[28:31]
    ds_read_b64_tr_b16 v[90:91], v246 offset:16896
    ds_read_b128 v[76:79], v244 offset:22528
    v_mfma_f32_16x16x32_bf16 v[44:47], v[124:127], v[104:107], v[44:47]
    v_fmac_f32 v162, v138, v158
    v_fmac_f32 v163, v142, v158
    v_mfma_f32_16x16x32_bf16 v[48:51], v[112:115], v[108:111], v[48:51]
    ds_read_b64_tr_b16 v[92:93], v247 offset:16384
    s_waitcnt lgkmcnt(10)
    ds_read_b64_tr_b16 v[94:95], v247 offset:16896
    buffer_load_dwordx4 v231, s[24:27], s72 offen offset:3072 lds
    v_mfma_f32_16x16x32_bf16 v[52:55], v[116:119], v[108:111], v[52:55]
    v_fmac_f32 v160, v131, v159
    v_fmac_f32 v161, v135, v159
    v_mfma_f32_16x16x32_bf16 v[56:59], v[120:123], v[108:111], v[56:59]
    v_fmac_f32 v162, v139, v159
    v_mfma_f32_16x16x32_bf16 v[60:63], v[124:127], v[108:111], v[60:63]
    v_fmac_f32 v163, v143, v159
    s_waitcnt lgkmcnt(6)
    v_mfma_f32_16x16x32_bf16 v[0:3], v[80:83], v[64:67], v[0:3]
    s_bfe_i32 s92, 0xf02f2ff0, s61
    s_add_u32 s92, s92, 13
    v_mfma_f32_16x16x32_bf16 v[4:7], v[84:87], v[64:67], v[4:7]
    ds_read2_b32 v[146:147], v152 offset0:108 offset1:160
    v_mfma_f32_16x16x32_bf16 v[128:131], a[32:35], a[32:35], 0
    v_mfma_f32_16x16x32_bf16 v[16:19], v[80:83], v[68:71], v[16:19]
    ds_read_b128 v[96:99], v245 offset:16384
    ds_read_b64_tr_b16 v[112:113], v248 offset:20480
    s_add_u32 m0, s93, 1024
    v_mfma_f32_16x16x32_bf16 v[20:23], v[84:87], v[68:71], v[20:23]
    v_lshl_add_u32 v145, v145, 7, v242
    buffer_load_dwordx4 v145, s[20:23], 0 offen lds
    v_mfma_f32_16x16x32_bf16 v[132:135], a[40:43], a[40:43], 0
    s_waitcnt lgkmcnt(3)
    v_mfma_f32_16x16x32_bf16 v[8:11], v[88:91], v[64:67], v[8:11]
    ds_read_b64_tr_b16 v[114:115], v248 offset:20992
    ds_read_b128 v[100:103], v245 offset:18432
    s_add_u32 m0, s68, 0
    v_mfma_f32_16x16x32_bf16 v[24:27], v[88:91], v[68:71], v[24:27]
    v_lshl_add_u32 v188, v188, 7, v241
    buffer_load_dwordx4 v188, s[20:23], 0 offen lds
    v_mfma_f32_16x16x32_bf16 v[136:139], a[48:51], a[48:51], 0
    v_mfma_f32_16x16x32_bf16 v[32:35], v[80:83], v[72:75], v[32:35]
    ds_read_b64_tr_b16 v[116:117], v249 offset:20480
    ds_read_b64_tr_b16 v[118:119], v249 offset:20992
    s_add_u32 m0, s68, 1024
    v_mfma_f32_16x16x32_bf16 v[36:39], v[84:87], v[72:75], v[36:39]
    v_lshl_add_u32 v189, v189, 7, v242
    buffer_load_dwordx4 v189, s[20:23], 0 offen lds
    v_mfma_f32_16x16x32_bf16 v[140:143], a[56:59], a[56:59], 0
    v_mfma_f32_16x16x32_bf16 v[40:43], v[88:91], v[72:75], v[40:43]
    ds_read_b128 v[104:107], v245 offset:20480
    ds_read_b64_tr_b16 v[120:121], v246 offset:20480
    v_mfma_f32_16x16x32_bf16 v[12:15], v[92:95], v[64:67], v[12:15]
    v_mfma_f32_16x16x32_bf16 v[128:131], a[36:39], a[36:39], v[128:131]
    v_mfma_f32_16x16x32_bf16 v[28:31], v[92:95], v[68:71], v[28:31]
    ds_read_b64_tr_b16 v[122:123], v246 offset:20992
    ds_read_b128 v[108:111], v245 offset:22528
    s_add_u32 m0, s68, 2048
    v_mfma_f32_16x16x32_bf16 v[44:47], v[92:95], v[72:75], v[44:47]
    v_lshl_add_u32 v190, v190, 7, v241
    buffer_load_dwordx4 v190, s[20:23], 0 offen lds
    v_mfma_f32_16x16x32_bf16 v[132:135], a[44:47], a[44:47], v[132:135]
    v_mfma_f32_16x16x32_bf16 v[48:51], v[80:83], v[76:79], v[48:51]
    ds_read_b64_tr_b16 v[124:125], v247 offset:20480
    ds_read_b64_tr_b16 v[126:127], v247 offset:20992
    s_add_u32 m0, s68, 3072
    v_mfma_f32_16x16x32_bf16 v[52:55], v[84:87], v[76:79], v[52:55]
    v_lshl_add_u32 v191, v191, 7, v242
    buffer_load_dwordx4 v191, s[20:23], 0 offen lds
    v_mfma_f32_16x16x32_bf16 v[136:139], a[52:55], a[52:55], v[136:139]
    v_mfma_f32_16x16x32_bf16 v[56:59], v[88:91], v[76:79], v[56:59]
    ds_read_b128 v[156:159], v154 offset:18432
    v_mfma_f32_16x16x32_bf16 v[60:63], v[92:95], v[76:79], v[60:63]
    v_mfma_f32_16x16x32_bf16 v[140:143], a[60:63], a[60:63], v[140:143]
    s_waitcnt lgkmcnt(0)
    s_waitcnt vmcnt(10)
    s_barrier
    v_mfma_f32_16x16x32_bf16 v[0:3], v[112:115], v[96:99], v[0:3]
    ds_read_b128 a[72:75], v148 offset:3072
    ds_read_b128 a[76:79], v149 offset:3072
    s_lshl_b32 s10, s92, 2
    v_xor_b32 v254, s10, v250
    ds_read2st64_b32 v[188:189], v254 offset0:0 offset1:4
    ds_read2st64_b32 v[190:191], v254 offset0:8 offset1:12
    v_mfma_f32_16x16x32_bf16 v[4:7], v[116:119], v[96:99], v[4:7]
    s_add_u32 m0, s93, 2048
    v_lshl_add_u32 v146, v146, 7, v241
    buffer_load_dwordx4 v146, s[20:23], 0 offen lds
    v_fmac_f32 v160, v128, v156
    v_fmac_f32 v161, v132, v156
    v_mfma_f32_16x16x32_bf16 v[16:19], v[112:115], v[100:103], v[16:19]
    ds_read_b128 v[64:67], v244 offset:32768
    ds_read_b64_tr_b16 v[80:81], v248 offset:32768
    s_lshl_b32 s72, s92, 15
    s_add_u32 s72, s72, s70
    v_mfma_f32_16x16x32_bf16 v[20:23], v[116:119], v[100:103], v[20:23]
    s_add_u32 m0, s69, 16384
    s_nop 0
    buffer_load_dwordx4 v228, s[24:27], s72 offen offset:0 lds
    v_fmac_f32 v162, v136, v156
    v_fmac_f32 v163, v140, v156
    v_mfma_f32_16x16x32_bf16 v[8:11], v[120:123], v[96:99], v[8:11]
    ds_read_b64_tr_b16 v[82:83], v248 offset:33280
    ds_read_b128 v[68:71], v244 offset:34816
    v_mfma_f32_16x16x32_bf16 v[24:27], v[120:123], v[100:103], v[24:27]
    v_fmac_f32 v160, v129, v157
    v_fmac_f32 v161, v133, v157
    v_mfma_f32_16x16x32_bf16 v[32:35], v[112:115], v[104:107], v[32:35]
    ds_read_b64_tr_b16 v[84:85], v249 offset:32768
    ds_read_b64_tr_b16 v[86:87], v249 offset:33280
    buffer_load_dwordx4 v229, s[24:27], s72 offen offset:1024 lds
    v_mfma_f32_16x16x32_bf16 v[36:39], v[116:119], v[104:107], v[36:39]
    v_fmac_f32 v162, v137, v157
    v_fmac_f32 v163, v141, v157
    v_mfma_f32_16x16x32_bf16 v[40:43], v[120:123], v[104:107], v[40:43]
    ds_read_b128 v[72:75], v244 offset:36864
    ds_read_b64_tr_b16 v[88:89], v246 offset:32768
    buffer_load_dwordx4 v230, s[24:27], s72 offen offset:2048 lds
    v_mfma_f32_16x16x32_bf16 v[12:15], v[124:127], v[96:99], v[12:15]
    v_fmac_f32 v160, v130, v158
    v_fmac_f32 v161, v134, v158
    v_mfma_f32_16x16x32_bf16 v[28:31], v[124:127], v[100:103], v[28:31]
    ds_read_b64_tr_b16 v[90:91], v246 offset:33280
    ds_read_b128 v[76:79], v244 offset:38912
    v_mfma_f32_16x16x32_bf16 v[44:47], v[124:127], v[104:107], v[44:47]
    v_fmac_f32 v162, v138, v158
    v_fmac_f32 v163, v142, v158
    v_mfma_f32_16x16x32_bf16 v[48:51], v[112:115], v[108:111], v[48:51]
    ds_read_b64_tr_b16 v[92:93], v247 offset:32768
    s_waitcnt lgkmcnt(10)
    ds_read_b64_tr_b16 v[94:95], v247 offset:33280
    buffer_load_dwordx4 v231, s[24:27], s72 offen offset:3072 lds
    v_mfma_f32_16x16x32_bf16 v[52:55], v[116:119], v[108:111], v[52:55]
    v_fmac_f32 v160, v131, v159
    v_fmac_f32 v161, v135, v159
    v_mfma_f32_16x16x32_bf16 v[56:59], v[120:123], v[108:111], v[56:59]
    v_fmac_f32 v162, v139, v159
    v_mfma_f32_16x16x32_bf16 v[60:63], v[124:127], v[108:111], v[60:63]
    v_fmac_f32 v163, v143, v159
    s_waitcnt lgkmcnt(6)
    v_mfma_f32_16x16x32_bf16 v[0:3], v[80:83], v[64:67], v[0:3]
    s_bfe_i32 s71, 0x2ffff02, s61
    s_add_u32 s71, s71, 14
    v_mfma_f32_16x16x32_bf16 v[4:7], v[84:87], v[64:67], v[4:7]
    ds_read2_b32 v[144:145], v251 offset0:12 offset1:64
    v_mfma_f32_16x16x32_bf16 v[16:19], v[80:83], v[68:71], v[16:19]
    ds_read_b128 v[96:99], v245 offset:32768
    ds_read_b64_tr_b16 v[112:113], v248 offset:36864
    s_add_u32 m0, s93, 3072
    v_mfma_f32_16x16x32_bf16 v[20:23], v[84:87], v[68:71], v[20:23]
    v_lshl_add_u32 v147, v147, 7, v242
    buffer_load_dwordx4 v147, s[20:23], 0 offen lds
    s_waitcnt lgkmcnt(3)
    v_mfma_f32_16x16x32_bf16 v[8:11], v[88:91], v[64:67], v[8:11]
    ds_read_b64_tr_b16 v[114:115], v248 offset:37376
    ds_read_b128 v[100:103], v245 offset:34816
    s_add_u32 m0, s68, 16384
    v_mfma_f32_16x16x32_bf16 v[24:27], v[88:91], v[68:71], v[24:27]
    v_lshl_add_u32 v188, v188, 7, v241
    buffer_load_dwordx4 v188, s[20:23], 0 offen lds
    v_mfma_f32_16x16x32_bf16 v[32:35], v[80:83], v[72:75], v[32:35]
    ds_read_b64_tr_b16 v[116:117], v249 offset:36864
    ds_read_b64_tr_b16 v[118:119], v249 offset:37376
    s_add_u32 m0, s68, 17408
    v_mfma_f32_16x16x32_bf16 v[36:39], v[84:87], v[72:75], v[36:39]
    v_lshl_add_u32 v189, v189, 7, v242
    buffer_load_dwordx4 v189, s[20:23], 0 offen lds
    v_mfma_f32_16x16x32_bf16 v[40:43], v[88:91], v[72:75], v[40:43]
    ds_read_b128 v[104:107], v245 offset:36864
    v_mfma_f32_16x16x32_bf16 v[12:15], v[92:95], v[64:67], v[12:15]
    ds_read_b64_tr_b16 v[120:121], v246 offset:36864
    v_mfma_f32_16x16x32_bf16 v[28:31], v[92:95], v[68:71], v[28:31]
    ds_read_b64_tr_b16 v[122:123], v246 offset:37376
    ds_read_b128 v[108:111], v245 offset:38912
    s_add_u32 m0, s68, 18432
    v_mfma_f32_16x16x32_bf16 v[44:47], v[92:95], v[72:75], v[44:47]
    v_lshl_add_u32 v190, v190, 7, v241
    buffer_load_dwordx4 v190, s[20:23], 0 offen lds
    v_mfma_f32_16x16x32_bf16 v[48:51], v[80:83], v[76:79], v[48:51]
    ds_read_b64_tr_b16 v[124:125], v247 offset:36864
    ds_read_b64_tr_b16 v[126:127], v247 offset:37376
    s_add_u32 m0, s68, 19456
    v_mfma_f32_16x16x32_bf16 v[52:55], v[84:87], v[76:79], v[52:55]
    v_lshl_add_u32 v191, v191, 7, v242
    buffer_load_dwordx4 v191, s[20:23], 0 offen lds
    v_mfma_f32_16x16x32_bf16 v[56:59], v[88:91], v[76:79], v[56:59]
    v_mfma_f32_16x16x32_bf16 v[60:63], v[92:95], v[76:79], v[60:63]
    s_waitcnt lgkmcnt(0)
    s_waitcnt vmcnt(10)
    s_barrier
    v_mfma_f32_16x16x32_bf16 v[0:3], v[112:115], v[96:99], v[0:3]
    ds_read_b128 a[80:83], v148 offset:0
    ds_read_b128 a[84:87], v149 offset:0
    s_lshl_b32 s10, s71, 2
    v_xor_b32 v254, s10, v250
    ds_read2st64_b32 v[188:189], v254 offset0:0 offset1:4
    v_mfma_f32_16x16x32_bf16 v[4:7], v[116:119], v[96:99], v[4:7]
    ds_read2st64_b32 v[190:191], v254 offset0:8 offset1:12
    s_add_u32 m0, s93, 4096
    v_lshl_add_u32 v144, v144, 7, v241
    buffer_load_dwordx4 v144, s[20:23], 0 offen lds
    v_mfma_f32_16x16x32_bf16 v[16:19], v[112:115], v[100:103], v[16:19]
    ds_read_b128 v[64:67], v244 offset:0
    ds_read_b64_tr_b16 v[80:81], v248 offset:0
    s_lshl_b32 s72, s71, 15
    v_mfma_f32_16x16x32_bf16 v[20:23], v[116:119], v[100:103], v[20:23]
    s_add_u32 s72, s72, s70
    s_add_u32 m0, s69, 32768
    s_nop 0
    buffer_load_dwordx4 v228, s[24:27], s72 offen offset:0 lds
    v_mfma_f32_16x16x32_bf16 v[8:11], v[120:123], v[96:99], v[8:11]
    ds_read_b64_tr_b16 v[82:83], v248 offset:512
    v_mfma_f32_16x16x32_bf16 v[24:27], v[120:123], v[100:103], v[24:27]
    ds_read_b128 v[68:71], v244 offset:2048
    v_mfma_f32_16x16x32_bf16 v[32:35], v[112:115], v[104:107], v[32:35]
    ds_read_b64_tr_b16 v[84:85], v249 offset:0
    ds_read_b64_tr_b16 v[86:87], v249 offset:512
    v_mfma_f32_16x16x32_bf16 v[36:39], v[116:119], v[104:107], v[36:39]
    buffer_load_dwordx4 v229, s[24:27], s72 offen offset:1024 lds
    v_mfma_f32_16x16x32_bf16 v[40:43], v[120:123], v[104:107], v[40:43]
    ds_read_b128 v[72:75], v244 offset:4096
    ds_read_b64_tr_b16 v[88:89], v246 offset:0
    v_mfma_f32_16x16x32_bf16 v[12:15], v[124:127], v[96:99], v[12:15]
    buffer_load_dwordx4 v230, s[24:27], s72 offen offset:2048 lds
    v_mfma_f32_16x16x32_bf16 v[28:31], v[124:127], v[100:103], v[28:31]
    ds_read_b64_tr_b16 v[90:91], v246 offset:512
    v_mfma_f32_16x16x32_bf16 v[44:47], v[124:127], v[104:107], v[44:47]
    ds_read_b128 v[76:79], v244 offset:6144
    v_mfma_f32_16x16x32_bf16 v[48:51], v[112:115], v[108:111], v[48:51]
    ds_read_b64_tr_b16 v[92:93], v247 offset:0
    s_waitcnt lgkmcnt(10)
    ds_read_b64_tr_b16 v[94:95], v247 offset:512
    v_mfma_f32_16x16x32_bf16 v[52:55], v[116:119], v[108:111], v[52:55]
    buffer_load_dwordx4 v231, s[24:27], s72 offen offset:3072 lds
    v_mfma_f32_16x16x32_bf16 v[56:59], v[120:123], v[108:111], v[56:59]
    v_mfma_f32_16x16x32_bf16 v[60:63], v[124:127], v[108:111], v[60:63]
    s_waitcnt lgkmcnt(6)
    v_mfma_f32_16x16x32_bf16 v[0:3], v[80:83], v[64:67], v[0:3]
    s_bfe_i32 s92, 0x2ff0f02f, s61
    s_add_u32 s92, s92, 15
    v_mfma_f32_16x16x32_bf16 v[4:7], v[84:87], v[64:67], v[4:7]
    ds_read2_b32 v[146:147], v251 offset0:112 offset1:164
    v_mfma_f32_16x16x32_bf16 v[16:19], v[80:83], v[68:71], v[16:19]
    ds_read_b128 v[96:99], v245 offset:0
    ds_read_b64_tr_b16 v[112:113], v248 offset:4096
    s_add_u32 m0, s93, 0
    v_mfma_f32_16x16x32_bf16 v[20:23], v[84:87], v[68:71], v[20:23]
    v_lshl_add_u32 v145, v145, 7, v242
    buffer_load_dwordx4 v145, s[20:23], 0 offen lds
    s_waitcnt lgkmcnt(3)
    v_mfma_f32_16x16x32_bf16 v[8:11], v[88:91], v[64:67], v[8:11]
    ds_read_b64_tr_b16 v[114:115], v248 offset:4608
    ds_read_b128 v[100:103], v245 offset:2048
    s_add_u32 m0, s68, 32768
    v_mfma_f32_16x16x32_bf16 v[24:27], v[88:91], v[68:71], v[24:27]
    v_lshl_add_u32 v188, v188, 7, v241
    buffer_load_dwordx4 v188, s[20:23], 0 offen lds
    v_mfma_f32_16x16x32_bf16 v[32:35], v[80:83], v[72:75], v[32:35]
    ds_read_b64_tr_b16 v[116:117], v249 offset:4096
    ds_read_b64_tr_b16 v[118:119], v249 offset:4608
    s_add_u32 m0, s68, 33792
    v_mfma_f32_16x16x32_bf16 v[36:39], v[84:87], v[72:75], v[36:39]
    v_lshl_add_u32 v189, v189, 7, v242
    buffer_load_dwordx4 v189, s[20:23], 0 offen lds
    v_mfma_f32_16x16x32_bf16 v[40:43], v[88:91], v[72:75], v[40:43]
    ds_read_b128 v[104:107], v245 offset:4096
    v_mfma_f32_16x16x32_bf16 v[12:15], v[92:95], v[64:67], v[12:15]
    ds_read_b64_tr_b16 v[120:121], v246 offset:4096
    v_mfma_f32_16x16x32_bf16 v[28:31], v[92:95], v[68:71], v[28:31]
    ds_read_b64_tr_b16 v[122:123], v246 offset:4608
    ds_read_b128 v[108:111], v245 offset:6144
    s_add_u32 m0, s68, 34816
    v_mfma_f32_16x16x32_bf16 v[44:47], v[92:95], v[72:75], v[44:47]
    v_lshl_add_u32 v190, v190, 7, v241
    buffer_load_dwordx4 v190, s[20:23], 0 offen lds
    v_mfma_f32_16x16x32_bf16 v[48:51], v[80:83], v[76:79], v[48:51]
    ds_read_b64_tr_b16 v[124:125], v247 offset:4096
    ds_read_b64_tr_b16 v[126:127], v247 offset:4608
    s_add_u32 m0, s68, 35840
    v_mfma_f32_16x16x32_bf16 v[52:55], v[84:87], v[76:79], v[52:55]
    v_lshl_add_u32 v191, v191, 7, v242
    buffer_load_dwordx4 v191, s[20:23], 0 offen lds
    v_mfma_f32_16x16x32_bf16 v[56:59], v[88:91], v[76:79], v[56:59]
    v_mfma_f32_16x16x32_bf16 v[60:63], v[92:95], v[76:79], v[60:63]
    s_waitcnt lgkmcnt(0)
    s_waitcnt vmcnt(10)
    s_barrier
    v_mfma_f32_16x16x32_bf16 v[0:3], v[112:115], v[96:99], v[0:3]
    ds_read_b128 a[88:91], v148 offset:2048
    ds_read_b128 a[92:95], v149 offset:2048
    s_lshl_b32 s10, s92, 2
    v_xor_b32 v254, s10, v250
    ds_read2st64_b32 v[188:189], v254 offset0:0 offset1:4
    v_mfma_f32_16x16x32_bf16 v[4:7], v[116:119], v[96:99], v[4:7]
    ds_read2st64_b32 v[190:191], v254 offset0:8 offset1:12
    s_add_u32 m0, s93, 1024
    v_lshl_add_u32 v146, v146, 7, v241
    buffer_load_dwordx4 v146, s[20:23], 0 offen lds
    v_mfma_f32_16x16x32_bf16 v[16:19], v[112:115], v[100:103], v[16:19]
    ds_read_b128 v[64:67], v244 offset:16384
    ds_read_b64_tr_b16 v[80:81], v248 offset:16384
    s_lshl_b32 s72, s92, 15
    v_mfma_f32_16x16x32_bf16 v[20:23], v[116:119], v[100:103], v[20:23]
    s_add_u32 s72, s72, s70
    s_add_u32 m0, s69, 0
    s_nop 0
    buffer_load_dwordx4 v228, s[24:27], s72 offen offset:0 lds
    v_mfma_f32_16x16x32_bf16 v[8:11], v[120:123], v[96:99], v[8:11]
    ds_read_b64_tr_b16 v[82:83], v248 offset:16896
    v_mfma_f32_16x16x32_bf16 v[24:27], v[120:123], v[100:103], v[24:27]
    ds_read_b128 v[68:71], v244 offset:18432
    v_mfma_f32_16x16x32_bf16 v[32:35], v[112:115], v[104:107], v[32:35]
    ds_read_b64_tr_b16 v[84:85], v249 offset:16384
    ds_read_b64_tr_b16 v[86:87], v249 offset:16896
    v_mfma_f32_16x16x32_bf16 v[36:39], v[116:119], v[104:107], v[36:39]
    buffer_load_dwordx4 v229, s[24:27], s72 offen offset:1024 lds
    v_mfma_f32_16x16x32_bf16 v[40:43], v[120:123], v[104:107], v[40:43]
    ds_read_b128 v[72:75], v244 offset:20480
    ds_read_b64_tr_b16 v[88:89], v246 offset:16384
    v_mfma_f32_16x16x32_bf16 v[12:15], v[124:127], v[96:99], v[12:15]
    buffer_load_dwordx4 v230, s[24:27], s72 offen offset:2048 lds
    v_mfma_f32_16x16x32_bf16 v[28:31], v[124:127], v[100:103], v[28:31]
    ds_read_b64_tr_b16 v[90:91], v246 offset:16896
    v_mfma_f32_16x16x32_bf16 v[44:47], v[124:127], v[104:107], v[44:47]
    ds_read_b128 v[76:79], v244 offset:22528
    v_mfma_f32_16x16x32_bf16 v[48:51], v[112:115], v[108:111], v[48:51]
    ds_read_b64_tr_b16 v[92:93], v247 offset:16384
    s_waitcnt lgkmcnt(10)
    ds_read_b64_tr_b16 v[94:95], v247 offset:16896
    v_mfma_f32_16x16x32_bf16 v[52:55], v[116:119], v[108:111], v[52:55]
    buffer_load_dwordx4 v231, s[24:27], s72 offen offset:3072 lds
    v_mfma_f32_16x16x32_bf16 v[56:59], v[120:123], v[108:111], v[56:59]
    v_mfma_f32_16x16x32_bf16 v[60:63], v[124:127], v[108:111], v[60:63]
    s_waitcnt lgkmcnt(6)
    v_mfma_f32_16x16x32_bf16 v[0:3], v[80:83], v[64:67], v[0:3]
    s_bfe_i32 s71, 0xff0202ff, s61
    s_add_u32 s71, s71, 16
    v_mfma_f32_16x16x32_bf16 v[4:7], v[84:87], v[64:67], v[4:7]
    ds_read2_b32 v[144:145], v152 offset0:12 offset1:64
    v_mfma_f32_16x16x32_bf16 v[128:131], a[0:3], a[64:67], 0
    v_mfma_f32_16x16x32_bf16 v[16:19], v[80:83], v[68:71], v[16:19]
    ds_read_b128 v[96:99], v245 offset:16384
    ds_read_b64_tr_b16 v[112:113], v248 offset:20480
    s_add_u32 m0, s93, 2048
    v_mfma_f32_16x16x32_bf16 v[20:23], v[84:87], v[68:71], v[20:23]
    v_lshl_add_u32 v147, v147, 7, v242
    buffer_load_dwordx4 v147, s[20:23], 0 offen lds
    v_mfma_f32_16x16x32_bf16 v[132:135], a[8:11], a[72:75], 0
    s_waitcnt lgkmcnt(3)
    v_mfma_f32_16x16x32_bf16 v[8:11], v[88:91], v[64:67], v[8:11]
    ds_read_b64_tr_b16 v[114:115], v248 offset:20992
    ds_read_b128 v[100:103], v245 offset:18432
    s_add_u32 m0, s68, 0
    v_mfma_f32_16x16x32_bf16 v[24:27], v[88:91], v[68:71], v[24:27]
    v_lshl_add_u32 v188, v188, 7, v241
    buffer_load_dwordx4 v188, s[20:23], 0 offen lds
    v_mfma_f32_16x16x32_bf16 v[136:139], a[16:19], a[80:83], 0
    v_mfma_f32_16x16x32_bf16 v[32:35], v[80:83], v[72:75], v[32:35]
    ds_read_b64_tr_b16 v[116:117], v249 offset:20480
    ds_read_b64_tr_b16 v[118:119], v249 offset:20992
    s_add_u32 m0, s68, 1024
    v_mfma_f32_16x16x32_bf16 v[36:39], v[84:87], v[72:75], v[36:39]
    v_lshl_add_u32 v189, v189, 7, v242
    buffer_load_dwordx4 v189, s[20:23], 0 offen lds
    v_mfma_f32_16x16x32_bf16 v[140:143], a[24:27], a[88:91], 0
    v_mfma_f32_16x16x32_bf16 v[40:43], v[88:91], v[72:75], v[40:43]
    ds_read_b128 v[104:107], v245 offset:20480
    ds_read_b64_tr_b16 v[120:121], v246 offset:20480
    v_mfma_f32_16x16x32_bf16 v[12:15], v[92:95], v[64:67], v[12:15]
    v_mfma_f32_16x16x32_bf16 v[128:131], a[4:7], a[68:71], v[128:131]
    v_mfma_f32_16x16x32_bf16 v[28:31], v[92:95], v[68:71], v[28:31]
    ds_read_b64_tr_b16 v[122:123], v246 offset:20992
    ds_read_b128 v[108:111], v245 offset:22528
    s_add_u32 m0, s68, 2048
    v_mfma_f32_16x16x32_bf16 v[44:47], v[92:95], v[72:75], v[44:47]
    v_lshl_add_u32 v190, v190, 7, v241
    buffer_load_dwordx4 v190, s[20:23], 0 offen lds
    v_mfma_f32_16x16x32_bf16 v[132:135], a[12:15], a[76:79], v[132:135]
    v_mfma_f32_16x16x32_bf16 v[48:51], v[80:83], v[76:79], v[48:51]
    ds_read_b64_tr_b16 v[124:125], v247 offset:20480
    ds_read_b64_tr_b16 v[126:127], v247 offset:20992
    s_add_u32 m0, s68, 3072
    v_mfma_f32_16x16x32_bf16 v[52:55], v[84:87], v[76:79], v[52:55]
    v_lshl_add_u32 v191, v191, 7, v242
    buffer_load_dwordx4 v191, s[20:23], 0 offen lds
    v_mfma_f32_16x16x32_bf16 v[136:139], a[20:23], a[84:87], v[136:139]
    v_mfma_f32_16x16x32_bf16 v[56:59], v[88:91], v[76:79], v[56:59]
    ds_read_b128 v[156:159], v154 offset:19456
    v_mfma_f32_16x16x32_bf16 v[60:63], v[92:95], v[76:79], v[60:63]
    v_mfma_f32_16x16x32_bf16 v[140:143], a[28:31], a[92:95], v[140:143]
    s_waitcnt lgkmcnt(0)
    s_waitcnt vmcnt(10)
    s_barrier
    v_mfma_f32_16x16x32_bf16 v[0:3], v[112:115], v[96:99], v[0:3]
    ds_read_b128 a[96:99], v150 offset:4096
    ds_read_b128 a[100:103], v151 offset:4096
    s_lshl_b32 s10, s71, 2
    v_xor_b32 v254, s10, v250
    ds_read2st64_b32 v[188:189], v254 offset0:0 offset1:4
    ds_read2st64_b32 v[190:191], v254 offset0:8 offset1:12
    v_mfma_f32_16x16x32_bf16 v[4:7], v[116:119], v[96:99], v[4:7]
    s_add_u32 m0, s93, 3072
    v_lshl_add_u32 v144, v144, 7, v241
    buffer_load_dwordx4 v144, s[20:23], 0 offen lds
    v_fmac_f32 v160, v128, v156
    v_fmac_f32 v161, v132, v156
    v_mfma_f32_16x16x32_bf16 v[16:19], v[112:115], v[100:103], v[16:19]
    ds_read_b128 v[64:67], v244 offset:32768
    ds_read_b64_tr_b16 v[80:81], v248 offset:32768
    s_lshl_b32 s72, s71, 15
    s_add_u32 s72, s72, s70
    v_mfma_f32_16x16x32_bf16 v[20:23], v[116:119], v[100:103], v[20:23]
    s_add_u32 m0, s69, 16384
    s_nop 0
    buffer_load_dwordx4 v228, s[24:27], s72 offen offset:0 lds
    v_fmac_f32 v162, v136, v156
    v_fmac_f32 v163, v140, v156
    v_mfma_f32_16x16x32_bf16 v[8:11], v[120:123], v[96:99], v[8:11]
    ds_read_b64_tr_b16 v[82:83], v248 offset:33280
    ds_read_b128 v[68:71], v244 offset:34816
    v_mfma_f32_16x16x32_bf16 v[24:27], v[120:123], v[100:103], v[24:27]
    v_fmac_f32 v160, v129, v157
    v_fmac_f32 v161, v133, v157
    v_mfma_f32_16x16x32_bf16 v[32:35], v[112:115], v[104:107], v[32:35]
    ds_read_b64_tr_b16 v[84:85], v249 offset:32768
    ds_read_b64_tr_b16 v[86:87], v249 offset:33280
    buffer_load_dwordx4 v229, s[24:27], s72 offen offset:1024 lds
    v_mfma_f32_16x16x32_bf16 v[36:39], v[116:119], v[104:107], v[36:39]
    v_fmac_f32 v162, v137, v157
    v_fmac_f32 v163, v141, v157
    v_mfma_f32_16x16x32_bf16 v[40:43], v[120:123], v[104:107], v[40:43]
    ds_read_b128 v[72:75], v244 offset:36864
    ds_read_b64_tr_b16 v[88:89], v246 offset:32768
    buffer_load_dwordx4 v230, s[24:27], s72 offen offset:2048 lds
    v_mfma_f32_16x16x32_bf16 v[12:15], v[124:127], v[96:99], v[12:15]
    v_fmac_f32 v160, v130, v158
    v_fmac_f32 v161, v134, v158
    v_mfma_f32_16x16x32_bf16 v[28:31], v[124:127], v[100:103], v[28:31]
    ds_read_b64_tr_b16 v[90:91], v246 offset:33280
    ds_read_b128 v[76:79], v244 offset:38912
    v_mfma_f32_16x16x32_bf16 v[44:47], v[124:127], v[104:107], v[44:47]
    v_fmac_f32 v162, v138, v158
    v_fmac_f32 v163, v142, v158
    v_mfma_f32_16x16x32_bf16 v[48:51], v[112:115], v[108:111], v[48:51]
    ds_read_b64_tr_b16 v[92:93], v247 offset:32768
    s_waitcnt lgkmcnt(10)
    ds_read_b64_tr_b16 v[94:95], v247 offset:33280
    buffer_load_dwordx4 v231, s[24:27], s72 offen offset:3072 lds
    v_mfma_f32_16x16x32_bf16 v[52:55], v[116:119], v[108:111], v[52:55]
    v_fmac_f32 v160, v131, v159
    v_fmac_f32 v161, v135, v159
    v_mfma_f32_16x16x32_bf16 v[56:59], v[120:123], v[108:111], v[56:59]
    v_fmac_f32 v162, v139, v159
    v_mfma_f32_16x16x32_bf16 v[60:63], v[124:127], v[108:111], v[60:63]
    v_fmac_f32 v163, v143, v159
    s_waitcnt lgkmcnt(6)
    v_mfma_f32_16x16x32_bf16 v[0:3], v[80:83], v[64:67], v[0:3]
    s_bfe_i32 s92, 0xf02f2ff0, s61
    s_add_u32 s92, s92, 17
    v_mfma_f32_16x16x32_bf16 v[4:7], v[84:87], v[64:67], v[4:7]
    ds_read2_b32 v[146:147], v152 offset0:112 offset1:164
    v_mfma_f32_16x16x32_bf16 v[128:131], a[32:35], a[64:67], 0
    v_mfma_f32_16x16x32_bf16 v[16:19], v[80:83], v[68:71], v[16:19]
    ds_read_b128 v[96:99], v245 offset:32768
    ds_read_b64_tr_b16 v[112:113], v248 offset:36864
    s_add_u32 m0, s93, 4096
    v_mfma_f32_16x16x32_bf16 v[20:23], v[84:87], v[68:71], v[20:23]
    v_lshl_add_u32 v145, v145, 7, v242
    buffer_load_dwordx4 v145, s[20:23], 0 offen lds
    v_mfma_f32_16x16x32_bf16 v[132:135], a[40:43], a[72:75], 0
    s_waitcnt lgkmcnt(3)
    v_mfma_f32_16x16x32_bf16 v[8:11], v[88:91], v[64:67], v[8:11]
    ds_read_b64_tr_b16 v[114:115], v248 offset:37376
    ds_read_b128 v[100:103], v245 offset:34816
    s_add_u32 m0, s68, 16384
    v_mfma_f32_16x16x32_bf16 v[24:27], v[88:91], v[68:71], v[24:27]
    v_lshl_add_u32 v188, v188, 7, v241
    buffer_load_dwordx4 v188, s[20:23], 0 offen lds
    v_mfma_f32_16x16x32_bf16 v[136:139], a[48:51], a[80:83], 0
    v_mfma_f32_16x16x32_bf16 v[32:35], v[80:83], v[72:75], v[32:35]
    ds_read_b64_tr_b16 v[116:117], v249 offset:36864
    ds_read_b64_tr_b16 v[118:119], v249 offset:37376
    s_add_u32 m0, s68, 17408
    v_mfma_f32_16x16x32_bf16 v[36:39], v[84:87], v[72:75], v[36:39]
    v_lshl_add_u32 v189, v189, 7, v242
    buffer_load_dwordx4 v189, s[20:23], 0 offen lds
    v_mfma_f32_16x16x32_bf16 v[140:143], a[56:59], a[88:91], 0
    v_mfma_f32_16x16x32_bf16 v[40:43], v[88:91], v[72:75], v[40:43]
    ds_read_b128 v[104:107], v245 offset:36864
    ds_read_b64_tr_b16 v[120:121], v246 offset:36864
    v_mfma_f32_16x16x32_bf16 v[12:15], v[92:95], v[64:67], v[12:15]
    v_mfma_f32_16x16x32_bf16 v[128:131], a[36:39], a[68:71], v[128:131]
    v_mfma_f32_16x16x32_bf16 v[28:31], v[92:95], v[68:71], v[28:31]
    ds_read_b64_tr_b16 v[122:123], v246 offset:37376
    ds_read_b128 v[108:111], v245 offset:38912
    s_add_u32 m0, s68, 18432
    v_mfma_f32_16x16x32_bf16 v[44:47], v[92:95], v[72:75], v[44:47]
    v_lshl_add_u32 v190, v190, 7, v241
    buffer_load_dwordx4 v190, s[20:23], 0 offen lds
    v_mfma_f32_16x16x32_bf16 v[132:135], a[44:47], a[76:79], v[132:135]
    v_mfma_f32_16x16x32_bf16 v[48:51], v[80:83], v[76:79], v[48:51]
    ds_read_b64_tr_b16 v[124:125], v247 offset:36864
    ds_read_b64_tr_b16 v[126:127], v247 offset:37376
    s_add_u32 m0, s68, 19456
    v_mfma_f32_16x16x32_bf16 v[52:55], v[84:87], v[76:79], v[52:55]
    v_lshl_add_u32 v191, v191, 7, v242
    buffer_load_dwordx4 v191, s[20:23], 0 offen lds
    v_mfma_f32_16x16x32_bf16 v[136:139], a[52:55], a[84:87], v[136:139]
    v_mfma_f32_16x16x32_bf16 v[56:59], v[88:91], v[76:79], v[56:59]
    ds_read_b128 v[156:159], v154 offset:20480
    v_mfma_f32_16x16x32_bf16 v[60:63], v[92:95], v[76:79], v[60:63]
    v_mfma_f32_16x16x32_bf16 v[140:143], a[60:63], a[92:95], v[140:143]
    s_waitcnt lgkmcnt(0)
    s_waitcnt vmcnt(10)
    s_barrier
    v_mfma_f32_16x16x32_bf16 v[0:3], v[112:115], v[96:99], v[0:3]
    ds_read_b128 a[104:107], v148 offset:1024
    ds_read_b128 a[108:111], v149 offset:1024
    s_lshl_b32 s10, s92, 2
    v_xor_b32 v254, s10, v250
    ds_read2st64_b32 v[188:189], v254 offset0:0 offset1:4
    ds_read2st64_b32 v[190:191], v254 offset0:8 offset1:12
    v_mfma_f32_16x16x32_bf16 v[4:7], v[116:119], v[96:99], v[4:7]
    s_add_u32 m0, s93, 0
    v_lshl_add_u32 v146, v146, 7, v241
    buffer_load_dwordx4 v146, s[20:23], 0 offen lds
    v_fmac_f32 v160, v128, v156
    v_fmac_f32 v161, v132, v156
    v_mfma_f32_16x16x32_bf16 v[16:19], v[112:115], v[100:103], v[16:19]
    ds_read_b128 v[64:67], v244 offset:0
    ds_read_b64_tr_b16 v[80:81], v248 offset:0
    s_lshl_b32 s72, s92, 15
    s_add_u32 s72, s72, s70
    v_mfma_f32_16x16x32_bf16 v[20:23], v[116:119], v[100:103], v[20:23]
    s_add_u32 m0, s69, 32768
    s_nop 0
    buffer_load_dwordx4 v228, s[24:27], s72 offen offset:0 lds
    v_fmac_f32 v162, v136, v156
    v_fmac_f32 v163, v140, v156
    v_mfma_f32_16x16x32_bf16 v[8:11], v[120:123], v[96:99], v[8:11]
    ds_read_b64_tr_b16 v[82:83], v248 offset:512
    ds_read_b128 v[68:71], v244 offset:2048
    buffer_load_dwordx4 v229, s[24:27], s72 offen offset:1024 lds
    v_mfma_f32_16x16x32_bf16 v[24:27], v[120:123], v[100:103], v[24:27]
    v_fmac_f32 v160, v129, v157
    v_fmac_f32 v161, v133, v157
    v_mfma_f32_16x16x32_bf16 v[32:35], v[112:115], v[104:107], v[32:35]
    ds_read_b64_tr_b16 v[84:85], v249 offset:0
    ds_read_b64_tr_b16 v[86:87], v249 offset:512
    v_mfma_f32_16x16x32_bf16 v[36:39], v[116:119], v[104:107], v[36:39]
    v_fmac_f32 v162, v137, v157
    v_fmac_f32 v163, v141, v157
    v_mfma_f32_16x16x32_bf16 v[40:43], v[120:123], v[104:107], v[40:43]
    ds_read_b128 v[72:75], v244 offset:4096
    ds_read_b64_tr_b16 v[88:89], v246 offset:0
    buffer_load_dwordx4 v230, s[24:27], s72 offen offset:2048 lds
    v_mfma_f32_16x16x32_bf16 v[12:15], v[124:127], v[96:99], v[12:15]
    v_fmac_f32 v160, v130, v158
    v_fmac_f32 v161, v134, v158
    v_mfma_f32_16x16x32_bf16 v[28:31], v[124:127], v[100:103], v[28:31]
    ds_read_b64_tr_b16 v[90:91], v246 offset:512
    ds_read_b128 v[76:79], v244 offset:6144
    buffer_load_dwordx4 v231, s[24:27], s72 offen offset:3072 lds
    v_mfma_f32_16x16x32_bf16 v[44:47], v[124:127], v[104:107], v[44:47]
    v_fmac_f32 v162, v138, v158
    v_fmac_f32 v163, v142, v158
    v_mfma_f32_16x16x32_bf16 v[48:51], v[112:115], v[108:111], v[48:51]
    ds_read_b64_tr_b16 v[92:93], v247 offset:0
    s_waitcnt lgkmcnt(10)
    ds_read_b64_tr_b16 v[94:95], v247 offset:512
    s_lshl_b32 s62, s57, 2
    s_mov_b64 exec, s[80:81]
    buffer_load_dword v234, off, s[48:51], s62 sc1
    s_mov_b64 exec, -1
    v_mfma_f32_16x16x32_bf16 v[52:55], v[116:119], v[108:111], v[52:55]
    v_fmac_f32 v160, v131, v159
    v_fmac_f32 v161, v135, v159
    v_mfma_f32_16x16x32_bf16 v[56:59], v[120:123], v[108:111], v[56:59]
    v_fmac_f32 v162, v139, v159
    v_mfma_f32_16x16x32_bf16 v[60:63], v[124:127], v[108:111], v[60:63]
    v_fmac_f32 v163, v143, v159
    s_waitcnt lgkmcnt(6)
    v_mfma_f32_16x16x32_bf16 v[0:3], v[80:83], v[64:67], v[0:3]
    s_bfe_i32 s71, 0x2ffff02, s61
    s_add_u32 s71, s71, 18
    v_mfma_f32_16x16x32_bf16 v[4:7], v[84:87], v[64:67], v[4:7]
    ds_read2_b32 v[144:145], v251 offset0:16 offset1:68
    v_mfma_f32_16x16x32_bf16 v[128:131], a[64:67], a[64:67], 0
    v_mfma_f32_16x16x32_bf16 v[16:19], v[80:83], v[68:71], v[16:19]
    ds_read_b128 v[96:99], v245 offset:0
    ds_read_b64_tr_b16 v[112:113], v248 offset:4096
    s_add_u32 m0, s93, 1024
    v_mfma_f32_16x16x32_bf16 v[20:23], v[84:87], v[68:71], v[20:23]
    v_lshl_add_u32 v147, v147, 7, v242
    buffer_load_dwordx4 v147, s[20:23], 0 offen lds
    v_mfma_f32_16x16x32_bf16 v[132:135], a[72:75], a[72:75], 0
    s_waitcnt lgkmcnt(3)
    v_mfma_f32_16x16x32_bf16 v[8:11], v[88:91], v[64:67], v[8:11]
    ds_read_b64_tr_b16 v[114:115], v248 offset:4608
    ds_read_b128 v[100:103], v245 offset:2048
    s_add_u32 m0, s68, 32768
    v_mfma_f32_16x16x32_bf16 v[24:27], v[88:91], v[68:71], v[24:27]
    v_lshl_add_u32 v188, v188, 7, v241
    buffer_load_dwordx4 v188, s[20:23], 0 offen lds
    v_mfma_f32_16x16x32_bf16 v[136:139], a[80:83], a[80:83], 0
    v_mfma_f32_16x16x32_bf16 v[32:35], v[80:83], v[72:75], v[32:35]
    ds_read_b64_tr_b16 v[116:117], v249 offset:4096
    ds_read_b64_tr_b16 v[118:119], v249 offset:4608
    s_add_u32 m0, s68, 33792
    v_mfma_f32_16x16x32_bf16 v[36:39], v[84:87], v[72:75], v[36:39]
    v_lshl_add_u32 v189, v189, 7, v242
    buffer_load_dwordx4 v189, s[20:23], 0 offen lds
    v_mfma_f32_16x16x32_bf16 v[140:143], a[88:91], a[88:91], 0
    v_mfma_f32_16x16x32_bf16 v[40:43], v[88:91], v[72:75], v[40:43]
    ds_read_b128 v[104:107], v245 offset:4096
    ds_read_b64_tr_b16 v[120:121], v246 offset:4096
    v_mfma_f32_16x16x32_bf16 v[12:15], v[92:95], v[64:67], v[12:15]
    v_mfma_f32_16x16x32_bf16 v[128:131], a[68:71], a[68:71], v[128:131]
    v_mfma_f32_16x16x32_bf16 v[28:31], v[92:95], v[68:71], v[28:31]
    ds_read_b64_tr_b16 v[122:123], v246 offset:4608
    ds_read_b128 v[108:111], v245 offset:6144
    s_add_u32 m0, s68, 34816
    v_mfma_f32_16x16x32_bf16 v[44:47], v[92:95], v[72:75], v[44:47]
    v_lshl_add_u32 v190, v190, 7, v241
    buffer_load_dwordx4 v190, s[20:23], 0 offen lds
    v_mfma_f32_16x16x32_bf16 v[132:135], a[76:79], a[76:79], v[132:135]
    v_mfma_f32_16x16x32_bf16 v[48:51], v[80:83], v[76:79], v[48:51]
    ds_read_b64_tr_b16 v[124:125], v247 offset:4096
    ds_read_b64_tr_b16 v[126:127], v247 offset:4608
    s_add_u32 m0, s68, 35840
    v_mfma_f32_16x16x32_bf16 v[52:55], v[84:87], v[76:79], v[52:55]
    v_lshl_add_u32 v191, v191, 7, v242
    buffer_load_dwordx4 v191, s[20:23], 0 offen lds
    v_mfma_f32_16x16x32_bf16 v[136:139], a[84:87], a[84:87], v[136:139]
    v_mfma_f32_16x16x32_bf16 v[56:59], v[88:91], v[76:79], v[56:59]
    ds_read_b128 v[156:159], v154 offset:21504
    v_mfma_f32_16x16x32_bf16 v[60:63], v[92:95], v[76:79], v[60:63]
    v_mfma_f32_16x16x32_bf16 v[140:143], a[92:95], a[92:95], v[140:143]
    s_waitcnt lgkmcnt(0)
    s_waitcnt vmcnt(11)
    s_barrier
    v_mfma_f32_16x16x32_bf16 v[0:3], v[112:115], v[96:99], v[0:3]
    ds_read_b128 a[112:115], v148 offset:3072
    ds_read_b128 a[116:119], v149 offset:3072
    s_lshl_b32 s10, s71, 2
    v_xor_b32 v254, s10, v250
    ds_read2st64_b32 v[188:189], v254 offset0:0 offset1:4
    ds_read2st64_b32 v[190:191], v254 offset0:8 offset1:12
    v_mfma_f32_16x16x32_bf16 v[4:7], v[116:119], v[96:99], v[4:7]
    s_add_u32 m0, s93, 2048
    v_lshl_add_u32 v144, v144, 7, v241
    buffer_load_dwordx4 v144, s[20:23], 0 offen lds
    v_fmac_f32 v160, v128, v156
    v_fmac_f32 v161, v132, v156
    v_mfma_f32_16x16x32_bf16 v[16:19], v[112:115], v[100:103], v[16:19]
    ds_read_b128 v[64:67], v244 offset:16384
    ds_read_b64_tr_b16 v[80:81], v248 offset:16384
    s_lshl_b32 s72, s71, 15
    s_add_u32 s72, s72, s70
    v_mfma_f32_16x16x32_bf16 v[20:23], v[116:119], v[100:103], v[20:23]
    s_add_u32 m0, s69, 0
    s_nop 0
    buffer_load_dwordx4 v228, s[24:27], s72 offen offset:0 lds
    v_fmac_f32 v162, v136, v156
    v_fmac_f32 v163, v140, v156
    v_mfma_f32_16x16x32_bf16 v[8:11], v[120:123], v[96:99], v[8:11]
    ds_read_b64_tr_b16 v[82:83], v248 offset:16896
    ds_read_b128 v[68:71], v244 offset:18432
    v_mfma_f32_16x16x32_bf16 v[24:27], v[120:123], v[100:103], v[24:27]
    v_fmac_f32 v160, v129, v157
    v_fmac_f32 v161, v133, v157
    v_mfma_f32_16x16x32_bf16 v[32:35], v[112:115], v[104:107], v[32:35]
    ds_read_b64_tr_b16 v[84:85], v249 offset:16384
    ds_read_b64_tr_b16 v[86:87], v249 offset:16896
    buffer_load_dwordx4 v229, s[24:27], s72 offen offset:1024 lds
    v_mfma_f32_16x16x32_bf16 v[36:39], v[116:119], v[104:107], v[36:39]
    v_fmac_f32 v162, v137, v157
    v_fmac_f32 v163, v141, v157
    v_mfma_f32_16x16x32_bf16 v[40:43], v[120:123], v[104:107], v[40:43]
    ds_read_b128 v[72:75], v244 offset:20480
    ds_read_b64_tr_b16 v[88:89], v246 offset:16384
    buffer_load_dwordx4 v230, s[24:27], s72 offen offset:2048 lds
    v_mfma_f32_16x16x32_bf16 v[12:15], v[124:127], v[96:99], v[12:15]
    v_fmac_f32 v160, v130, v158
    v_fmac_f32 v161, v134, v158
    v_mfma_f32_16x16x32_bf16 v[28:31], v[124:127], v[100:103], v[28:31]
    ds_read_b64_tr_b16 v[90:91], v246 offset:16896
    ds_read_b128 v[76:79], v244 offset:22528
    v_mfma_f32_16x16x32_bf16 v[44:47], v[124:127], v[104:107], v[44:47]
    v_fmac_f32 v162, v138, v158
    v_fmac_f32 v163, v142, v158
    v_mfma_f32_16x16x32_bf16 v[48:51], v[112:115], v[108:111], v[48:51]
    ds_read_b64_tr_b16 v[92:93], v247 offset:16384
    s_waitcnt lgkmcnt(10)
    ds_read_b64_tr_b16 v[94:95], v247 offset:16896
    buffer_load_dwordx4 v231, s[24:27], s72 offen offset:3072 lds
    v_mfma_f32_16x16x32_bf16 v[52:55], v[116:119], v[108:111], v[52:55]
    v_fmac_f32 v160, v131, v159
    v_fmac_f32 v161, v135, v159
    v_mfma_f32_16x16x32_bf16 v[56:59], v[120:123], v[108:111], v[56:59]
    v_fmac_f32 v162, v139, v159
    v_mfma_f32_16x16x32_bf16 v[60:63], v[124:127], v[108:111], v[60:63]
    v_fmac_f32 v163, v143, v159
    s_waitcnt lgkmcnt(6)
    v_mfma_f32_16x16x32_bf16 v[0:3], v[80:83], v[64:67], v[0:3]
    s_bfe_i32 s92, 0x2ff0f02f, s61
    s_add_u32 s92, s92, 19
    v_mfma_f32_16x16x32_bf16 v[4:7], v[84:87], v[64:67], v[4:7]
    ds_read2_b32 v[146:147], v251 offset0:116 offset1:168
    v_mfma_f32_16x16x32_bf16 v[16:19], v[80:83], v[68:71], v[16:19]
    ds_read_b128 v[96:99], v245 offset:16384
    ds_read_b64_tr_b16 v[112:113], v248 offset:20480
    s_add_u32 m0, s93, 3072
    v_mfma_f32_16x16x32_bf16 v[20:23], v[84:87], v[68:71], v[20:23]
    v_lshl_add_u32 v145, v145, 7, v242
    buffer_load_dwordx4 v145, s[20:23], 0 offen lds
    s_waitcnt lgkmcnt(3)
    v_mfma_f32_16x16x32_bf16 v[8:11], v[88:91], v[64:67], v[8:11]
    ds_read_b64_tr_b16 v[114:115], v248 offset:20992
    ds_read_b128 v[100:103], v245 offset:18432
    s_add_u32 m0, s68, 0
    v_mfma_f32_16x16x32_bf16 v[24:27], v[88:91], v[68:71], v[24:27]
    v_lshl_add_u32 v188, v188, 7, v241
    buffer_load_dwordx4 v188, s[20:23], 0 offen lds
    v_mfma_f32_16x16x32_bf16 v[32:35], v[80:83], v[72:75], v[32:35]
    ds_read_b64_tr_b16 v[116:117], v249 offset:20480
    ds_read_b64_tr_b16 v[118:119], v249 offset:20992
    s_add_u32 m0, s68, 1024
    v_mfma_f32_16x16x32_bf16 v[36:39], v[84:87], v[72:75], v[36:39]
    v_lshl_add_u32 v189, v189, 7, v242
    buffer_load_dwordx4 v189, s[20:23], 0 offen lds
    v_mfma_f32_16x16x32_bf16 v[40:43], v[88:91], v[72:75], v[40:43]
    ds_read_b128 v[104:107], v245 offset:20480
    v_mfma_f32_16x16x32_bf16 v[12:15], v[92:95], v[64:67], v[12:15]
    ds_read_b64_tr_b16 v[120:121], v246 offset:20480
    v_mfma_f32_16x16x32_bf16 v[28:31], v[92:95], v[68:71], v[28:31]
    ds_read_b64_tr_b16 v[122:123], v246 offset:20992
    ds_read_b128 v[108:111], v245 offset:22528
    s_add_u32 m0, s68, 2048
    v_mfma_f32_16x16x32_bf16 v[44:47], v[92:95], v[72:75], v[44:47]
    v_lshl_add_u32 v190, v190, 7, v241
    buffer_load_dwordx4 v190, s[20:23], 0 offen lds
    v_mfma_f32_16x16x32_bf16 v[48:51], v[80:83], v[76:79], v[48:51]
    ds_read_b64_tr_b16 v[124:125], v247 offset:20480
    ds_read_b64_tr_b16 v[126:127], v247 offset:20992
    s_add_u32 m0, s68, 3072
    v_mfma_f32_16x16x32_bf16 v[52:55], v[84:87], v[76:79], v[52:55]
    v_lshl_add_u32 v191, v191, 7, v242
    buffer_load_dwordx4 v191, s[20:23], 0 offen lds
    v_mfma_f32_16x16x32_bf16 v[56:59], v[88:91], v[76:79], v[56:59]
    v_mfma_f32_16x16x32_bf16 v[60:63], v[92:95], v[76:79], v[60:63]
    s_waitcnt lgkmcnt(0)
    s_waitcnt vmcnt(10)
    s_barrier
    v_mfma_f32_16x16x32_bf16 v[0:3], v[112:115], v[96:99], v[0:3]
    ds_read_b128 a[120:123], v148 offset:0
    ds_read_b128 a[124:127], v149 offset:0
    s_lshl_b32 s10, s92, 2
    v_xor_b32 v254, s10, v250
    ds_read2st64_b32 v[188:189], v254 offset0:0 offset1:4
    v_mfma_f32_16x16x32_bf16 v[4:7], v[116:119], v[96:99], v[4:7]
    ds_read2st64_b32 v[190:191], v254 offset0:8 offset1:12
    s_add_u32 m0, s93, 4096
    v_lshl_add_u32 v146, v146, 7, v241
    buffer_load_dwordx4 v146, s[20:23], 0 offen lds
    v_mfma_f32_16x16x32_bf16 v[16:19], v[112:115], v[100:103], v[16:19]
    ds_read_b128 v[64:67], v244 offset:32768
    ds_read_b64_tr_b16 v[80:81], v248 offset:32768
    s_lshl_b32 s72, s92, 15
    v_mfma_f32_16x16x32_bf16 v[20:23], v[116:119], v[100:103], v[20:23]
    s_add_u32 s72, s72, s70
    s_add_u32 m0, s69, 16384
    s_nop 0
    buffer_load_dwordx4 v228, s[24:27], s72 offen offset:0 lds
    v_mfma_f32_16x16x32_bf16 v[8:11], v[120:123], v[96:99], v[8:11]
    ds_read_b64_tr_b16 v[82:83], v248 offset:33280
    v_mfma_f32_16x16x32_bf16 v[24:27], v[120:123], v[100:103], v[24:27]
    ds_read_b128 v[68:71], v244 offset:34816
    v_mfma_f32_16x16x32_bf16 v[32:35], v[112:115], v[104:107], v[32:35]
    ds_read_b64_tr_b16 v[84:85], v249 offset:32768
    ds_read_b64_tr_b16 v[86:87], v249 offset:33280
    v_mfma_f32_16x16x32_bf16 v[36:39], v[116:119], v[104:107], v[36:39]
    buffer_load_dwordx4 v229, s[24:27], s72 offen offset:1024 lds
    v_mfma_f32_16x16x32_bf16 v[40:43], v[120:123], v[104:107], v[40:43]
    ds_read_b128 v[72:75], v244 offset:36864
    ds_read_b64_tr_b16 v[88:89], v246 offset:32768
    v_mfma_f32_16x16x32_bf16 v[12:15], v[124:127], v[96:99], v[12:15]
    buffer_load_dwordx4 v230, s[24:27], s72 offen offset:2048 lds
    v_mfma_f32_16x16x32_bf16 v[28:31], v[124:127], v[100:103], v[28:31]
    ds_read_b64_tr_b16 v[90:91], v246 offset:33280
    v_mfma_f32_16x16x32_bf16 v[44:47], v[124:127], v[104:107], v[44:47]
    ds_read_b128 v[76:79], v244 offset:38912
    v_mfma_f32_16x16x32_bf16 v[48:51], v[112:115], v[108:111], v[48:51]
    ds_read_b64_tr_b16 v[92:93], v247 offset:32768
    s_waitcnt lgkmcnt(10)
    ds_read_b64_tr_b16 v[94:95], v247 offset:33280
    v_mfma_f32_16x16x32_bf16 v[52:55], v[116:119], v[108:111], v[52:55]
    buffer_load_dwordx4 v231, s[24:27], s72 offen offset:3072 lds
    v_mfma_f32_16x16x32_bf16 v[56:59], v[120:123], v[108:111], v[56:59]
    v_mfma_f32_16x16x32_bf16 v[60:63], v[124:127], v[108:111], v[60:63]
    s_waitcnt lgkmcnt(6)
    v_mfma_f32_16x16x32_bf16 v[0:3], v[80:83], v[64:67], v[0:3]
    s_bfe_i32 s71, 0xff0202ff, s61
    s_add_u32 s71, s71, 20
    v_mfma_f32_16x16x32_bf16 v[4:7], v[84:87], v[64:67], v[4:7]
    ds_read2_b32 v[144:145], v152 offset0:16 offset1:68
    v_mfma_f32_16x16x32_bf16 v[16:19], v[80:83], v[68:71], v[16:19]
    ds_read_b128 v[96:99], v245 offset:32768
    ds_read_b64_tr_b16 v[112:113], v248 offset:36864
    s_add_u32 m0, s93, 0
    v_mfma_f32_16x16x32_bf16 v[20:23], v[84:87], v[68:71], v[20:23]
    v_lshl_add_u32 v147, v147, 7, v242
    buffer_load_dwordx4 v147, s[20:23], 0 offen lds
    s_waitcnt lgkmcnt(3)
    v_mfma_f32_16x16x32_bf16 v[8:11], v[88:91], v[64:67], v[8:11]
    ds_read_b64_tr_b16 v[114:115], v248 offset:37376
    ds_read_b128 v[100:103], v245 offset:34816
    s_add_u32 m0, s68, 16384
    v_mfma_f32_16x16x32_bf16 v[24:27], v[88:91], v[68:71], v[24:27]
    v_lshl_add_u32 v188, v188, 7, v241
    buffer_load_dwordx4 v188, s[20:23], 0 offen lds
    v_mfma_f32_16x16x32_bf16 v[32:35], v[80:83], v[72:75], v[32:35]
    ds_read_b64_tr_b16 v[116:117], v249 offset:36864
    ds_read_b64_tr_b16 v[118:119], v249 offset:37376
    s_add_u32 m0, s68, 17408
    v_mfma_f32_16x16x32_bf16 v[36:39], v[84:87], v[72:75], v[36:39]
    v_lshl_add_u32 v189, v189, 7, v242
    buffer_load_dwordx4 v189, s[20:23], 0 offen lds
    v_mfma_f32_16x16x32_bf16 v[40:43], v[88:91], v[72:75], v[40:43]
    ds_read_b128 v[104:107], v245 offset:36864
    v_mfma_f32_16x16x32_bf16 v[12:15], v[92:95], v[64:67], v[12:15]
    ds_read_b64_tr_b16 v[120:121], v246 offset:36864
    v_mfma_f32_16x16x32_bf16 v[28:31], v[92:95], v[68:71], v[28:31]
    ds_read_b64_tr_b16 v[122:123], v246 offset:37376
    ds_read_b128 v[108:111], v245 offset:38912
    s_add_u32 m0, s68, 18432
    v_mfma_f32_16x16x32_bf16 v[44:47], v[92:95], v[72:75], v[44:47]
    v_lshl_add_u32 v190, v190, 7, v241
    buffer_load_dwordx4 v190, s[20:23], 0 offen lds
    v_mfma_f32_16x16x32_bf16 v[48:51], v[80:83], v[76:79], v[48:51]
    ds_read_b64_tr_b16 v[124:125], v247 offset:36864
    ds_read_b64_tr_b16 v[126:127], v247 offset:37376
    s_add_u32 m0, s68, 19456
    v_mfma_f32_16x16x32_bf16 v[52:55], v[84:87], v[76:79], v[52:55]
    v_lshl_add_u32 v191, v191, 7, v242
    buffer_load_dwordx4 v191, s[20:23], 0 offen lds
    v_mfma_f32_16x16x32_bf16 v[56:59], v[88:91], v[76:79], v[56:59]
    v_mfma_f32_16x16x32_bf16 v[60:63], v[92:95], v[76:79], v[60:63]
    s_waitcnt lgkmcnt(0)
    s_waitcnt vmcnt(10)
    s_barrier
    v_mfma_f32_16x16x32_bf16 v[0:3], v[112:115], v[96:99], v[0:3]
    ds_read_b128 a[128:131], v148 offset:2048
    ds_read_b128 a[132:135], v149 offset:2048
    s_lshl_b32 s10, s71, 2
    v_xor_b32 v254, s10, v250
    ds_read2st64_b32 v[188:189], v254 offset0:0 offset1:4
    v_mfma_f32_16x16x32_bf16 v[4:7], v[116:119], v[96:99], v[4:7]
    ds_read2st64_b32 v[190:191], v254 offset0:8 offset1:12
    s_add_u32 m0, s93, 1024
    v_lshl_add_u32 v144, v144, 7, v241
    buffer_load_dwordx4 v144, s[20:23], 0 offen lds
    v_mfma_f32_16x16x32_bf16 v[16:19], v[112:115], v[100:103], v[16:19]
    ds_read_b128 v[64:67], v244 offset:0
    ds_read_b64_tr_b16 v[80:81], v248 offset:0
    s_lshl_b32 s72, s71, 15
    v_mfma_f32_16x16x32_bf16 v[20:23], v[116:119], v[100:103], v[20:23]
    s_add_u32 s72, s72, s70
    s_add_u32 m0, s69, 32768
    s_nop 0
    buffer_load_dwordx4 v228, s[24:27], s72 offen offset:0 lds
    v_mfma_f32_16x16x32_bf16 v[8:11], v[120:123], v[96:99], v[8:11]
    ds_read_b64_tr_b16 v[82:83], v248 offset:512
    v_mfma_f32_16x16x32_bf16 v[24:27], v[120:123], v[100:103], v[24:27]
    ds_read_b128 v[68:71], v244 offset:2048
    v_mfma_f32_16x16x32_bf16 v[32:35], v[112:115], v[104:107], v[32:35]
    ds_read_b64_tr_b16 v[84:85], v249 offset:0
    ds_read_b64_tr_b16 v[86:87], v249 offset:512
    v_mfma_f32_16x16x32_bf16 v[36:39], v[116:119], v[104:107], v[36:39]
    buffer_load_dwordx4 v229, s[24:27], s72 offen offset:1024 lds
    v_mfma_f32_16x16x32_bf16 v[40:43], v[120:123], v[104:107], v[40:43]
    ds_read_b128 v[72:75], v244 offset:4096
    ds_read_b64_tr_b16 v[88:89], v246 offset:0
    v_mfma_f32_16x16x32_bf16 v[12:15], v[124:127], v[96:99], v[12:15]
    buffer_load_dwordx4 v230, s[24:27], s72 offen offset:2048 lds
    v_mfma_f32_16x16x32_bf16 v[28:31], v[124:127], v[100:103], v[28:31]
    ds_read_b64_tr_b16 v[90:91], v246 offset:512
    v_mfma_f32_16x16x32_bf16 v[44:47], v[124:127], v[104:107], v[44:47]
    ds_read_b128 v[76:79], v244 offset:6144
    v_mfma_f32_16x16x32_bf16 v[48:51], v[112:115], v[108:111], v[48:51]
    ds_read_b64_tr_b16 v[92:93], v247 offset:0
    s_waitcnt lgkmcnt(10)
    ds_read_b64_tr_b16 v[94:95], v247 offset:512
    v_mfma_f32_16x16x32_bf16 v[52:55], v[116:119], v[108:111], v[52:55]
    buffer_load_dwordx4 v231, s[24:27], s72 offen offset:3072 lds
    v_mfma_f32_16x16x32_bf16 v[56:59], v[120:123], v[108:111], v[56:59]
    v_mfma_f32_16x16x32_bf16 v[60:63], v[124:127], v[108:111], v[60:63]
    s_waitcnt lgkmcnt(6)
    v_mfma_f32_16x16x32_bf16 v[0:3], v[80:83], v[64:67], v[0:3]
    s_bfe_i32 s92, 0xf02f2ff0, s61
    s_add_u32 s92, s92, 21
    v_mfma_f32_16x16x32_bf16 v[4:7], v[84:87], v[64:67], v[4:7]
    ds_read2_b32 v[146:147], v152 offset0:116 offset1:168
    v_mfma_f32_16x16x32_bf16 v[16:19], v[80:83], v[68:71], v[16:19]
    ds_read_b128 v[96:99], v245 offset:0
    ds_read_b64_tr_b16 v[112:113], v248 offset:4096
    s_add_u32 m0, s93, 2048
    v_mfma_f32_16x16x32_bf16 v[20:23], v[84:87], v[68:71], v[20:23]
    v_lshl_add_u32 v145, v145, 7, v242
    buffer_load_dwordx4 v145, s[20:23], 0 offen lds
    s_waitcnt lgkmcnt(3)
    v_mfma_f32_16x16x32_bf16 v[8:11], v[88:91], v[64:67], v[8:11]
    ds_read_b64_tr_b16 v[114:115], v248 offset:4608
    ds_read_b128 v[100:103], v245 offset:2048
    s_add_u32 m0, s68, 32768
    v_mfma_f32_16x16x32_bf16 v[24:27], v[88:91], v[68:71], v[24:27]
    v_lshl_add_u32 v188, v188, 7, v241
    buffer_load_dwordx4 v188, s[20:23], 0 offen lds
    v_mfma_f32_16x16x32_bf16 v[32:35], v[80:83], v[72:75], v[32:35]
    ds_read_b64_tr_b16 v[116:117], v249 offset:4096
    ds_read_b64_tr_b16 v[118:119], v249 offset:4608
    s_add_u32 m0, s68, 33792
    v_mfma_f32_16x16x32_bf16 v[36:39], v[84:87], v[72:75], v[36:39]
    v_lshl_add_u32 v189, v189, 7, v242
    buffer_load_dwordx4 v189, s[20:23], 0 offen lds
    v_mfma_f32_16x16x32_bf16 v[40:43], v[88:91], v[72:75], v[40:43]
    ds_read_b128 v[104:107], v245 offset:4096
    v_mfma_f32_16x16x32_bf16 v[12:15], v[92:95], v[64:67], v[12:15]
    ds_read_b64_tr_b16 v[120:121], v246 offset:4096
    v_mfma_f32_16x16x32_bf16 v[28:31], v[92:95], v[68:71], v[28:31]
    ds_read_b64_tr_b16 v[122:123], v246 offset:4608
    ds_read_b128 v[108:111], v245 offset:6144
    s_add_u32 m0, s68, 34816
    v_mfma_f32_16x16x32_bf16 v[44:47], v[92:95], v[72:75], v[44:47]
    v_lshl_add_u32 v190, v190, 7, v241
    buffer_load_dwordx4 v190, s[20:23], 0 offen lds
    v_mfma_f32_16x16x32_bf16 v[48:51], v[80:83], v[76:79], v[48:51]
    ds_read_b64_tr_b16 v[124:125], v247 offset:4096
    ds_read_b64_tr_b16 v[126:127], v247 offset:4608
    s_add_u32 m0, s68, 35840
    v_mfma_f32_16x16x32_bf16 v[52:55], v[84:87], v[76:79], v[52:55]
    v_lshl_add_u32 v191, v191, 7, v242
    buffer_load_dwordx4 v191, s[20:23], 0 offen lds
    v_mfma_f32_16x16x32_bf16 v[56:59], v[88:91], v[76:79], v[56:59]
    v_mfma_f32_16x16x32_bf16 v[60:63], v[92:95], v[76:79], v[60:63]
    s_waitcnt lgkmcnt(0)
    s_waitcnt vmcnt(10)
    s_barrier
    v_mfma_f32_16x16x32_bf16 v[0:3], v[112:115], v[96:99], v[0:3]
    ds_read_b128 a[136:139], v150 offset:4096
    ds_read_b128 a[140:143], v151 offset:4096
    s_lshl_b32 s10, s92, 2
    v_xor_b32 v254, s10, v250
    ds_read2st64_b32 v[188:189], v254 offset0:0 offset1:4
    v_mfma_f32_16x16x32_bf16 v[4:7], v[116:119], v[96:99], v[4:7]
    ds_read2st64_b32 v[190:191], v254 offset0:8 offset1:12
    s_add_u32 m0, s93, 3072
    v_lshl_add_u32 v146, v146, 7, v241
    buffer_load_dwordx4 v146, s[20:23], 0 offen lds
    v_mfma_f32_16x16x32_bf16 v[16:19], v[112:115], v[100:103], v[16:19]
    ds_read_b128 v[64:67], v244 offset:16384
    ds_read_b64_tr_b16 v[80:81], v248 offset:16384
    s_lshl_b32 s72, s92, 15
    v_mfma_f32_16x16x32_bf16 v[20:23], v[116:119], v[100:103], v[20:23]
    s_add_u32 s72, s72, s70
    s_add_u32 m0, s69, 0
    s_nop 0
    buffer_load_dwordx4 v228, s[24:27], s72 offen offset:0 lds
    v_mfma_f32_16x16x32_bf16 v[8:11], v[120:123], v[96:99], v[8:11]
    ds_read_b64_tr_b16 v[82:83], v248 offset:16896
    v_mfma_f32_16x16x32_bf16 v[24:27], v[120:123], v[100:103], v[24:27]
    ds_read_b128 v[68:71], v244 offset:18432
    v_mfma_f32_16x16x32_bf16 v[32:35], v[112:115], v[104:107], v[32:35]
    ds_read_b64_tr_b16 v[84:85], v249 offset:16384
    ds_read_b64_tr_b16 v[86:87], v249 offset:16896
    v_mfma_f32_16x16x32_bf16 v[36:39], v[116:119], v[104:107], v[36:39]
    buffer_load_dwordx4 v229, s[24:27], s72 offen offset:1024 lds
    v_mfma_f32_16x16x32_bf16 v[40:43], v[120:123], v[104:107], v[40:43]
    ds_read_b128 v[72:75], v244 offset:20480
    ds_read_b64_tr_b16 v[88:89], v246 offset:16384
    v_mfma_f32_16x16x32_bf16 v[12:15], v[124:127], v[96:99], v[12:15]
    buffer_load_dwordx4 v230, s[24:27], s72 offen offset:2048 lds
    v_mfma_f32_16x16x32_bf16 v[28:31], v[124:127], v[100:103], v[28:31]
    ds_read_b64_tr_b16 v[90:91], v246 offset:16896
    v_mfma_f32_16x16x32_bf16 v[44:47], v[124:127], v[104:107], v[44:47]
    ds_read_b128 v[76:79], v244 offset:22528
    v_mfma_f32_16x16x32_bf16 v[48:51], v[112:115], v[108:111], v[48:51]
    ds_read_b64_tr_b16 v[92:93], v247 offset:16384
    s_waitcnt lgkmcnt(10)
    ds_read_b64_tr_b16 v[94:95], v247 offset:16896
    v_mfma_f32_16x16x32_bf16 v[52:55], v[116:119], v[108:111], v[52:55]
    buffer_load_dwordx4 v231, s[24:27], s72 offen offset:3072 lds
    v_mfma_f32_16x16x32_bf16 v[56:59], v[120:123], v[108:111], v[56:59]
    v_mfma_f32_16x16x32_bf16 v[60:63], v[124:127], v[108:111], v[60:63]
    s_cmp_lg_u32 s56, 0
    s_cbranch_scc1 L_rdy
    s_mov_b32 s97, 0x10000
    s_lshl_b32 s62, s57, 2
L_rloop:
    v_readfirstlane_b32 s63, v234
    s_nop 0
    s_cmp_ge_u32 s63, 8
    s_cbranch_scc1 L_rdy
    s_sub_u32 s97, s97, 1
    s_cbranch_scc1 L_rdy
    s_sleep 4
    buffer_load_dword v234, off, s[48:51], s62 sc1
    s_waitcnt vmcnt(0)
    s_branch L_rloop
L_rdy:
    s_waitcnt lgkmcnt(6)
    v_mfma_f32_16x16x32_bf16 v[0:3], v[80:83], v[64:67], v[0:3]
    s_bfe_i32 s71, 0x2ffff02, s61
    s_add_u32 s71, s71, 22
    v_mfma_f32_16x16x32_bf16 v[4:7], v[84:87], v[64:67], v[4:7]
    ds_read2_b32 v[144:145], v251 offset0:20 offset1:72
    v_mfma_f32_16x16x32_bf16 v[16:19], v[80:83], v[68:71], v[16:19]
    ds_read_b128 v[96:99], v245 offset:16384
    ds_read_b64_tr_b16 v[112:113], v248 offset:20480
    s_add_u32 m0, s93, 4096
    v_mfma_f32_16x16x32_bf16 v[20:23], v[84:87], v[68:71], v[20:23]
    v_lshl_add_u32 v147, v147, 7, v242
    buffer_load_dwordx4 v147, s[20:23], 0 offen lds
    s_waitcnt lgkmcnt(3)
    v_mfma_f32_16x16x32_bf16 v[8:11], v[88:91], v[64:67], v[8:11]
    ds_read_b64_tr_b16 v[114:115], v248 offset:20992
    ds_read_b128 v[100:103], v245 offset:18432
    s_add_u32 m0, s68, 0
    v_mfma_f32_16x16x32_bf16 v[24:27], v[88:91], v[68:71], v[24:27]
    v_lshl_add_u32 v188, v188, 7, v241
    buffer_load_dwordx4 v188, s[20:23], 0 offen lds
    v_mfma_f32_16x16x32_bf16 v[32:35], v[80:83], v[72:75], v[32:35]
    ds_read_b64_tr_b16 v[116:117], v249 offset:20480
    ds_read_b64_tr_b16 v[118:119], v249 offset:20992
    s_add_u32 m0, s68, 1024
    v_mfma_f32_16x16x32_bf16 v[36:39], v[84:87], v[72:75], v[36:39]
    v_lshl_add_u32 v189, v189, 7, v242
    buffer_load_dwordx4 v189, s[20:23], 0 offen lds
    v_mfma_f32_16x16x32_bf16 v[40:43], v[88:91], v[72:75], v[40:43]
    ds_read_b128 v[104:107], v245 offset:20480
    v_mfma_f32_16x16x32_bf16 v[12:15], v[92:95], v[64:67], v[12:15]
    ds_read_b64_tr_b16 v[120:121], v246 offset:20480
    v_mfma_f32_16x16x32_bf16 v[28:31], v[92:95], v[68:71], v[28:31]
    ds_read_b64_tr_b16 v[122:123], v246 offset:20992
    ds_read_b128 v[108:111], v245 offset:22528
    s_add_u32 m0, s68, 2048
    v_mfma_f32_16x16x32_bf16 v[44:47], v[92:95], v[72:75], v[44:47]
    v_lshl_add_u32 v190, v190, 7, v241
    buffer_load_dwordx4 v190, s[20:23], 0 offen lds
    v_mfma_f32_16x16x32_bf16 v[48:51], v[80:83], v[76:79], v[48:51]
    ds_read_b64_tr_b16 v[124:125], v247 offset:20480
    ds_read_b64_tr_b16 v[126:127], v247 offset:20992
    s_add_u32 m0, s68, 3072
    v_mfma_f32_16x16x32_bf16 v[52:55], v[84:87], v[76:79], v[52:55]
    v_lshl_add_u32 v191, v191, 7, v242
    buffer_load_dwordx4 v191, s[20:23], 0 offen lds
    v_mfma_f32_16x16x32_bf16 v[56:59], v[88:91], v[76:79], v[56:59]
    v_mfma_f32_16x16x32_bf16 v[60:63], v[92:95], v[76:79], v[60:63]
    s_waitcnt lgkmcnt(0)
    s_waitcnt vmcnt(10)
    s_barrier
    v_mfma_f32_16x16x32_bf16 v[0:3], v[112:115], v[96:99], v[0:3]
    ds_read_b128 a[144:147], v148 offset:1024
    ds_read_b128 a[148:151], v149 offset:1024
    s_lshl_b32 s10, s71, 2
    v_xor_b32 v254, s10, v250
    ds_read2st64_b32 v[188:189], v254 offset0:0 offset1:4
    v_mfma_f32_16x16x32_bf16 v[4:7], v[116:119], v[96:99], v[4:7]
    ds_read2st64_b32 v[190:191], v254 offset0:8 offset1:12
    s_add_u32 m0, s93, 0
    v_lshl_add_u32 v144, v144, 7, v241
    buffer_load_dwordx4 v144, s[20:23], 0 offen lds
    v_mfma_f32_16x16x32_bf16 v[16:19], v[112:115], v[100:103], v[16:19]
    ds_read_b128 v[64:67], v244 offset:32768
    ds_read_b64_tr_b16 v[80:81], v248 offset:32768
    s_cmp_eq_u32 s71, 24
    s_cselect_b32 s72, s64, s70
    v_mfma_f32_16x16x32_bf16 v[20:23], v[116:119], v[100:103], v[20:23]
    s_lshl_b32 s3, s71, 15
    s_add_u32 s72, s72, s3
    s_add_u32 m0, s69, 16384
    s_nop 0
    buffer_load_dwordx4 v228, s[24:27], s72 offen offset:0 lds
    v_mfma_f32_16x16x32_bf16 v[8:11], v[120:123], v[96:99], v[8:11]
    ds_read_b64_tr_b16 v[82:83], v248 offset:33280
    v_mfma_f32_16x16x32_bf16 v[24:27], v[120:123], v[100:103], v[24:27]
    ds_read_b128 v[68:71], v244 offset:34816
    v_mfma_f32_16x16x32_bf16 v[32:35], v[112:115], v[104:107], v[32:35]
    ds_read_b64_tr_b16 v[84:85], v249 offset:32768
    ds_read_b64_tr_b16 v[86:87], v249 offset:33280
    v_mfma_f32_16x16x32_bf16 v[36:39], v[116:119], v[104:107], v[36:39]
    buffer_load_dwordx4 v229, s[24:27], s72 offen offset:1024 lds
    v_mfma_f32_16x16x32_bf16 v[40:43], v[120:123], v[104:107], v[40:43]
    ds_read_b128 v[72:75], v244 offset:36864
    ds_read_b64_tr_b16 v[88:89], v246 offset:32768
    v_mfma_f32_16x16x32_bf16 v[12:15], v[124:127], v[96:99], v[12:15]
    buffer_load_dwordx4 v230, s[24:27], s72 offen offset:2048 lds
    v_mfma_f32_16x16x32_bf16 v[28:31], v[124:127], v[100:103], v[28:31]
    ds_read_b64_tr_b16 v[90:91], v246 offset:33280
    v_mfma_f32_16x16x32_bf16 v[44:47], v[124:127], v[104:107], v[44:47]
    ds_read_b128 v[76:79], v244 offset:38912
    v_mfma_f32_16x16x32_bf16 v[48:51], v[112:115], v[108:111], v[48:51]
    ds_read_b64_tr_b16 v[92:93], v247 offset:32768
    s_waitcnt lgkmcnt(10)
    ds_read_b64_tr_b16 v[94:95], v247 offset:33280
    v_mfma_f32_16x16x32_bf16 v[52:55], v[116:119], v[108:111], v[52:55]
    buffer_load_dwordx4 v231, s[24:27], s72 offen offset:3072 lds
    v_mfma_f32_16x16x32_bf16 v[56:59], v[120:123], v[108:111], v[56:59]
    v_mfma_f32_16x16x32_bf16 v[60:63], v[124:127], v[108:111], v[60:63]
    s_waitcnt lgkmcnt(6)
    v_mfma_f32_16x16x32_bf16 v[0:3], v[80:83], v[64:67], v[0:3]
    s_bfe_i32 s92, 0xff0f00f, s61
    s_add_u32 s92, s92, 23
    v_mfma_f32_16x16x32_bf16 v[4:7], v[84:87], v[64:67], v[4:7]
    ds_read2_b32 v[146:147], v251 offset0:120 offset1:172
    v_mfma_f32_16x16x32_bf16 v[16:19], v[80:83], v[68:71], v[16:19]
    ds_read_b128 v[96:99], v245 offset:32768
    ds_read_b64_tr_b16 v[112:113], v248 offset:36864
    s_add_u32 m0, s93, 1024
    v_mfma_f32_16x16x32_bf16 v[20:23], v[84:87], v[68:71], v[20:23]
    v_lshl_add_u32 v145, v145, 7, v242
    buffer_load_dwordx4 v145, s[20:23], 0 offen lds
    s_waitcnt lgkmcnt(3)
    v_mfma_f32_16x16x32_bf16 v[8:11], v[88:91], v[64:67], v[8:11]
    ds_read_b64_tr_b16 v[114:115], v248 offset:37376
    ds_read_b128 v[100:103], v245 offset:34816
    s_add_u32 m0, s68, 16384
    v_mfma_f32_16x16x32_bf16 v[24:27], v[88:91], v[68:71], v[24:27]
    v_lshl_add_u32 v188, v188, 7, v241
    buffer_load_dwordx4 v188, s[20:23], 0 offen lds
    v_mfma_f32_16x16x32_bf16 v[32:35], v[80:83], v[72:75], v[32:35]
    ds_read_b64_tr_b16 v[116:117], v249 offset:36864
    ds_read_b64_tr_b16 v[118:119], v249 offset:37376
    s_add_u32 m0, s68, 17408
    v_mfma_f32_16x16x32_bf16 v[36:39], v[84:87], v[72:75], v[36:39]
    v_lshl_add_u32 v189, v189, 7, v242
    buffer_load_dwordx4 v189, s[20:23], 0 offen lds
    v_mfma_f32_16x16x32_bf16 v[40:43], v[88:91], v[72:75], v[40:43]
    ds_read_b128 v[104:107], v245 offset:36864
    v_mfma_f32_16x16x32_bf16 v[12:15], v[92:95], v[64:67], v[12:15]
    ds_read_b64_tr_b16 v[120:121], v246 offset:36864
    v_mfma_f32_16x16x32_bf16 v[28:31], v[92:95], v[68:71], v[28:31]
    ds_read_b64_tr_b16 v[122:123], v246 offset:37376
    ds_read_b128 v[108:111], v245 offset:38912
    s_add_u32 m0, s68, 18432
    v_mfma_f32_16x16x32_bf16 v[44:47], v[92:95], v[72:75], v[44:47]
    v_lshl_add_u32 v190, v190, 7, v241
    buffer_load_dwordx4 v190, s[20:23], 0 offen lds
    v_mfma_f32_16x16x32_bf16 v[48:51], v[80:83], v[76:79], v[48:51]
    ds_read_b64_tr_b16 v[124:125], v247 offset:36864
    ds_read_b64_tr_b16 v[126:127], v247 offset:37376
    s_add_u32 m0, s68, 19456
    v_mfma_f32_16x16x32_bf16 v[52:55], v[84:87], v[76:79], v[52:55]
    v_lshl_add_u32 v191, v191, 7, v242
    buffer_load_dwordx4 v191, s[20:23], 0 offen lds
    v_mfma_f32_16x16x32_bf16 v[56:59], v[88:91], v[76:79], v[56:59]
    v_mfma_f32_16x16x32_bf16 v[60:63], v[92:95], v[76:79], v[60:63]
    s_waitcnt lgkmcnt(0)
    s_waitcnt vmcnt(10)
    s_barrier
    v_mfma_f32_16x16x32_bf16 v[0:3], v[112:115], v[96:99], v[0:3]
    ds_read_b128 a[152:155], v148 offset:3072
    ds_read_b128 a[156:159], v149 offset:3072
    s_lshl_b32 s10, s92, 2
    v_xor_b32 v254, s10, v250
    ds_read2st64_b32 v[188:189], v254 offset0:0 offset1:4
    v_mfma_f32_16x16x32_bf16 v[4:7], v[116:119], v[96:99], v[4:7]
    ds_read2st64_b32 v[190:191], v254 offset0:8 offset1:12
    s_add_u32 m0, s93, 2048
    v_lshl_add_u32 v146, v146, 7, v241
    buffer_load_dwordx4 v146, s[20:23], 0 offen lds
    v_mfma_f32_16x16x32_bf16 v[16:19], v[112:115], v[100:103], v[16:19]
    ds_read_b128 v[64:67], v244 offset:0
    ds_read_b64_tr_b16 v[80:81], v248 offset:0
    s_lshl_b32 s72, s92, 15
    v_mfma_f32_16x16x32_bf16 v[20:23], v[116:119], v[100:103], v[20:23]
    s_add_u32 s72, s72, s70
    s_add_u32 m0, s69, 32768
    s_nop 0
    buffer_load_dwordx4 v228, s[24:27], s72 offen offset:0 lds
    v_mfma_f32_16x16x32_bf16 v[8:11], v[120:123], v[96:99], v[8:11]
    ds_read_b64_tr_b16 v[82:83], v248 offset:512
    v_mfma_f32_16x16x32_bf16 v[24:27], v[120:123], v[100:103], v[24:27]
    ds_read_b128 v[68:71], v244 offset:2048
    v_mfma_f32_16x16x32_bf16 v[32:35], v[112:115], v[104:107], v[32:35]
    ds_read_b64_tr_b16 v[84:85], v249 offset:0
    ds_read_b64_tr_b16 v[86:87], v249 offset:512
    v_mfma_f32_16x16x32_bf16 v[36:39], v[116:119], v[104:107], v[36:39]
    buffer_load_dwordx4 v229, s[24:27], s72 offen offset:1024 lds
    v_mfma_f32_16x16x32_bf16 v[40:43], v[120:123], v[104:107], v[40:43]
    ds_read_b128 v[72:75], v244 offset:4096
    ds_read_b64_tr_b16 v[88:89], v246 offset:0
    v_mfma_f32_16x16x32_bf16 v[12:15], v[124:127], v[96:99], v[12:15]
    buffer_load_dwordx4 v230, s[24:27], s72 offen offset:2048 lds
    v_mfma_f32_16x16x32_bf16 v[28:31], v[124:127], v[100:103], v[28:31]
    ds_read_b64_tr_b16 v[90:91], v246 offset:512
    v_mfma_f32_16x16x32_bf16 v[44:47], v[124:127], v[104:107], v[44:47]
    ds_read_b128 v[76:79], v244 offset:6144
    v_mfma_f32_16x16x32_bf16 v[48:51], v[112:115], v[108:111], v[48:51]
    ds_read_b64_tr_b16 v[92:93], v247 offset:0
    s_waitcnt lgkmcnt(10)
    ds_read_b64_tr_b16 v[94:95], v247 offset:512
    v_mfma_f32_16x16x32_bf16 v[52:55], v[116:119], v[108:111], v[52:55]
    buffer_load_dwordx4 v231, s[24:27], s72 offen offset:3072 lds
    v_mfma_f32_16x16x32_bf16 v[56:59], v[120:123], v[108:111], v[56:59]
    v_mfma_f32_16x16x32_bf16 v[60:63], v[124:127], v[108:111], v[60:63]
    s_waitcnt lgkmcnt(6)
    v_mfma_f32_16x16x32_bf16 v[0:3], v[80:83], v[64:67], v[0:3]
    s_bfe_i32 s71, 0xf00000f, s61
    s_add_u32 s71, s71, 24
    v_mfma_f32_16x16x32_bf16 v[4:7], v[84:87], v[64:67], v[4:7]
    ds_read2_b32 v[144:145], v152 offset0:20 offset1:72
    v_mfma_f32_16x16x32_bf16 v[16:19], v[80:83], v[68:71], v[16:19]
    ds_read_b128 v[96:99], v245 offset:0
    ds_read_b64_tr_b16 v[112:113], v248 offset:4096
    s_add_u32 m0, s93, 3072
    v_mfma_f32_16x16x32_bf16 v[20:23], v[84:87], v[68:71], v[20:23]
    v_lshl_add_u32 v147, v147, 7, v242
    buffer_load_dwordx4 v147, s[20:23], 0 offen lds
    s_waitcnt lgkmcnt(3)
    v_mfma_f32_16x16x32_bf16 v[8:11], v[88:91], v[64:67], v[8:11]
    ds_read_b64_tr_b16 v[114:115], v248 offset:4608
    ds_read_b128 v[100:103], v245 offset:2048
    s_add_u32 m0, s68, 32768
    v_mfma_f32_16x16x32_bf16 v[24:27], v[88:91], v[68:71], v[24:27]
    v_lshl_add_u32 v188, v188, 7, v241
    buffer_load_dwordx4 v188, s[20:23], 0 offen lds
    v_mfma_f32_16x16x32_bf16 v[32:35], v[80:83], v[72:75], v[32:35]
    ds_read_b64_tr_b16 v[116:117], v249 offset:4096
    ds_read_b64_tr_b16 v[118:119], v249 offset:4608
    s_add_u32 m0, s68, 33792
    v_mfma_f32_16x16x32_bf16 v[36:39], v[84:87], v[72:75], v[36:39]
    v_lshl_add_u32 v189, v189, 7, v242
    buffer_load_dwordx4 v189, s[20:23], 0 offen lds
    v_mfma_f32_16x16x32_bf16 v[40:43], v[88:91], v[72:75], v[40:43]
    ds_read_b128 v[104:107], v245 offset:4096
    v_mfma_f32_16x16x32_bf16 v[12:15], v[92:95], v[64:67], v[12:15]
    ds_read_b64_tr_b16 v[120:121], v246 offset:4096
    v_mfma_f32_16x16x32_bf16 v[28:31], v[92:95], v[68:71], v[28:31]
    ds_read_b64_tr_b16 v[122:123], v246 offset:4608
    ds_read_b128 v[108:111], v245 offset:6144
    s_add_u32 m0, s68, 34816
    v_mfma_f32_16x16x32_bf16 v[44:47], v[92:95], v[72:75], v[44:47]
    v_lshl_add_u32 v190, v190, 7, v241
    buffer_load_dwordx4 v190, s[20:23], 0 offen lds
    v_mfma_f32_16x16x32_bf16 v[48:51], v[80:83], v[76:79], v[48:51]
    ds_read_b64_tr_b16 v[124:125], v247 offset:4096
    ds_read_b64_tr_b16 v[126:127], v247 offset:4608
    s_add_u32 m0, s68, 35840
    v_mfma_f32_16x16x32_bf16 v[52:55], v[84:87], v[76:79], v[52:55]
    v_lshl_add_u32 v191, v191, 7, v242
    buffer_load_dwordx4 v191, s[20:23], 0 offen lds
    v_mfma_f32_16x16x32_bf16 v[56:59], v[88:91], v[76:79], v[56:59]
    v_mfma_f32_16x16x32_bf16 v[60:63], v[92:95], v[76:79], v[60:63]
    s_waitcnt lgkmcnt(0)
    s_waitcnt vmcnt(10)
    s_barrier
    v_mfma_f32_16x16x32_bf16 v[0:3], v[112:115], v[96:99], v[0:3]
    ds_read_b128 a[160:163], v148 offset:0
    ds_read_b128 a[164:167], v149 offset:0
    s_lshl_b32 s10, s71, 2
    v_xor_b32 v254, s10, v250
    ds_read2st64_b32 v[188:189], v254 offset0:0 offset1:4
    v_mfma_f32_16x16x32_bf16 v[4:7], v[116:119], v[96:99], v[4:7]
    ds_read2st64_b32 v[190:191], v254 offset0:8 offset1:12
    s_add_u32 m0, s93, 4096
    v_lshl_add_u32 v144, v144, 7, v241
    buffer_load_dwordx4 v144, s[20:23], 0 offen lds
    v_mfma_f32_16x16x32_bf16 v[16:19], v[112:115], v[100:103], v[16:19]
    ds_read_b128 v[64:67], v244 offset:16384
    ds_read_b64_tr_b16 v[80:81], v248 offset:16384
    s_cmp_eq_u32 s71, 24
    s_cselect_b32 s72, s64, s70
    v_mfma_f32_16x16x32_bf16 v[20:23], v[116:119], v[100:103], v[20:23]
    s_lshl_b32 s3, s71, 15
    s_add_u32 s72, s72, s3
    s_add_u32 m0, s69, 0
    s_nop 0
    buffer_load_dwordx4 v228, s[24:27], s72 offen offset:0 lds
    v_mfma_f32_16x16x32_bf16 v[8:11], v[120:123], v[96:99], v[8:11]
    ds_read_b64_tr_b16 v[82:83], v248 offset:16896
    v_mfma_f32_16x16x32_bf16 v[24:27], v[120:123], v[100:103], v[24:27]
    ds_read_b128 v[68:71], v244 offset:18432
    v_mfma_f32_16x16x32_bf16 v[32:35], v[112:115], v[104:107], v[32:35]
    ds_read_b64_tr_b16 v[84:85], v249 offset:16384
    ds_read_b64_tr_b16 v[86:87], v249 offset:16896
    v_mfma_f32_16x16x32_bf16 v[36:39], v[116:119], v[104:107], v[36:39]
    buffer_load_dwordx4 v229, s[24:27], s72 offen offset:1024 lds
    v_mfma_f32_16x16x32_bf16 v[40:43], v[120:123], v[104:107], v[40:43]
    ds_read_b128 v[72:75], v244 offset:20480
    ds_read_b64_tr_b16 v[88:89], v246 offset:16384
    v_mfma_f32_16x16x32_bf16 v[12:15], v[124:127], v[96:99], v[12:15]
    buffer_load_dwordx4 v230, s[24:27], s72 offen offset:2048 lds
    v_mfma_f32_16x16x32_bf16 v[28:31], v[124:127], v[100:103], v[28:31]
    ds_read_b64_tr_b16 v[90:91], v246 offset:16896
    v_mfma_f32_16x16x32_bf16 v[44:47], v[124:127], v[104:107], v[44:47]
    ds_read_b128 v[76:79], v244 offset:22528
    v_mfma_f32_16x16x32_bf16 v[48:51], v[112:115], v[108:111], v[48:51]
    ds_read_b64_tr_b16 v[92:93], v247 offset:16384
    s_waitcnt lgkmcnt(10)
    ds_read_b64_tr_b16 v[94:95], v247 offset:16896
    v_mfma_f32_16x16x32_bf16 v[52:55], v[116:119], v[108:111], v[52:55]
    buffer_load_dwordx4 v231, s[24:27], s72 offen offset:3072 lds
    v_mfma_f32_16x16x32_bf16 v[56:59], v[120:123], v[108:111], v[56:59]
    v_mfma_f32_16x16x32_bf16 v[60:63], v[124:127], v[108:111], v[60:63]
    s_waitcnt lgkmcnt(6)
    v_mfma_f32_16x16x32_bf16 v[0:3], v[80:83], v[64:67], v[0:3]
    ds_read2_b32 v[146:147], v152 offset0:120 offset1:172
    v_mfma_f32_16x16x32_bf16 v[4:7], v[84:87], v[64:67], v[4:7]
    v_mfma_f32_16x16x32_bf16 v[16:19], v[80:83], v[68:71], v[16:19]
    ds_read_b128 v[96:99], v245 offset:16384
    ds_read_b64_tr_b16 v[112:113], v248 offset:20480
    s_add_u32 m0, s93, 0
    v_mfma_f32_16x16x32_bf16 v[20:23], v[84:87], v[68:71], v[20:23]
    v_lshl_add_u32 v145, v145, 7, v242
    buffer_load_dwordx4 v145, s[20:23], 0 offen lds
    s_waitcnt lgkmcnt(3)
    v_mfma_f32_16x16x32_bf16 v[8:11], v[88:91], v[64:67], v[8:11]
    ds_read_b64_tr_b16 v[114:115], v248 offset:20992
    ds_read_b128 v[100:103], v245 offset:18432
    s_add_u32 m0, s68, 0
    v_mfma_f32_16x16x32_bf16 v[24:27], v[88:91], v[68:71], v[24:27]
    v_lshl_add_u32 v188, v188, 7, v241
    buffer_load_dwordx4 v188, s[20:23], 0 offen lds
    v_mfma_f32_16x16x32_bf16 v[32:35], v[80:83], v[72:75], v[32:35]
    ds_read_b64_tr_b16 v[116:117], v249 offset:20480
    ds_read_b64_tr_b16 v[118:119], v249 offset:20992
    s_add_u32 m0, s68, 1024
    v_mfma_f32_16x16x32_bf16 v[36:39], v[84:87], v[72:75], v[36:39]
    v_lshl_add_u32 v189, v189, 7, v242
    buffer_load_dwordx4 v189, s[20:23], 0 offen lds
    v_mfma_f32_16x16x32_bf16 v[40:43], v[88:91], v[72:75], v[40:43]
    ds_read_b128 v[104:107], v245 offset:20480
    v_mfma_f32_16x16x32_bf16 v[12:15], v[92:95], v[64:67], v[12:15]
    ds_read_b64_tr_b16 v[120:121], v246 offset:20480
    v_mfma_f32_16x16x32_bf16 v[28:31], v[92:95], v[68:71], v[28:31]
    ds_read_b64_tr_b16 v[122:123], v246 offset:20992
    ds_read_b128 v[108:111], v245 offset:22528
    s_add_u32 m0, s68, 2048
    v_mfma_f32_16x16x32_bf16 v[44:47], v[92:95], v[72:75], v[44:47]
    v_lshl_add_u32 v190, v190, 7, v241
    buffer_load_dwordx4 v190, s[20:23], 0 offen lds
    v_mfma_f32_16x16x32_bf16 v[48:51], v[80:83], v[76:79], v[48:51]
    ds_read_b64_tr_b16 v[124:125], v247 offset:20480
    ds_read_b64_tr_b16 v[126:127], v247 offset:20992
    s_add_u32 m0, s68, 3072
    v_mfma_f32_16x16x32_bf16 v[52:55], v[84:87], v[76:79], v[52:55]
    v_lshl_add_u32 v191, v191, 7, v242
    buffer_load_dwordx4 v191, s[20:23], 0 offen lds
    v_mfma_f32_16x16x32_bf16 v[56:59], v[88:91], v[76:79], v[56:59]
    v_mfma_f32_16x16x32_bf16 v[60:63], v[92:95], v[76:79], v[60:63]
    s_waitcnt lgkmcnt(0)
    s_waitcnt vmcnt(10)
    s_barrier
    v_mfma_f32_16x16x32_bf16 v[0:3], v[112:115], v[96:99], v[0:3]
    ds_read_b128 a[168:171], v148 offset:2048
    ds_read_b128 a[172:175], v149 offset:2048
    s_add_u32 m0, s93, 1024
    v_mfma_f32_16x16x32_bf16 v[4:7], v[116:119], v[96:99], v[4:7]
    v_lshl_add_u32 v146, v146, 7, v241
    buffer_load_dwordx4 v146, s[20:23], 0 offen lds
    s_lshl_b32 s62, s56, 10
    v_mfma_f32_16x16x32_bf16 v[16:19], v[112:115], v[100:103], v[16:19]
    ds_read_b128 v[64:67], v244 offset:32768
    v_mfma_f32_16x16x32_bf16 v[20:23], v[116:119], v[100:103], v[20:23]
    ds_read_b64_tr_b16 v[80:81], v248 offset:32768
    v_mfma_f32_16x16x32_bf16 v[8:11], v[120:123], v[96:99], v[8:11]
    ds_read_b64_tr_b16 v[82:83], v248 offset:33280
    ds_read_b128 v[68:71], v244 offset:34816
    v_mfma_f32_16x16x32_bf16 v[24:27], v[120:123], v[100:103], v[24:27]
    v_add_u32 v236, s62, v154
    v_mfma_f32_16x16x32_bf16 v[32:35], v[112:115], v[104:107], v[32:35]
    ds_read_b64_tr_b16 v[84:85], v249 offset:32768
    v_mfma_f32_16x16x32_bf16 v[36:39], v[116:119], v[104:107], v[36:39]
    ds_read_b64_tr_b16 v[86:87], v249 offset:33280
    v_mfma_f32_16x16x32_bf16 v[40:43], v[120:123], v[104:107], v[40:43]
    ds_read_b128 v[72:75], v244 offset:36864
    ds_read_b64_tr_b16 v[88:89], v246 offset:32768
    v_mfma_f32_16x16x32_bf16 v[12:15], v[124:127], v[96:99], v[12:15]
    ds_write_b128 v236, v[176:179] offset:0
    v_mfma_f32_16x16x32_bf16 v[28:31], v[124:127], v[100:103], v[28:31]
    ds_read_b64_tr_b16 v[90:91], v246 offset:33280
    v_mfma_f32_16x16x32_bf16 v[44:47], v[124:127], v[104:107], v[44:47]
    ds_read_b128 v[76:79], v244 offset:38912
    v_mfma_f32_16x16x32_bf16 v[48:51], v[112:115], v[108:111], v[48:51]
    ds_read_b64_tr_b16 v[92:93], v247 offset:32768
    ds_read_b64_tr_b16 v[94:95], v247 offset:33280
    v_mfma_f32_16x16x32_bf16 v[52:55], v[116:119], v[108:111], v[52:55]
    s_waitcnt lgkmcnt(10)
    ds_write_b128 v236, v[180:183] offset:4096
    v_mfma_f32_16x16x32_bf16 v[56:59], v[120:123], v[108:111], v[56:59]
    v_mfma_f32_16x16x32_bf16 v[60:63], v[124:127], v[108:111], v[60:63]
    s_waitcnt lgkmcnt(8)
    v_mfma_f32_16x16x32_bf16 v[0:3], v[80:83], v[64:67], v[0:3]
    ds_read2_b32 v[144:145], v153 offset0:0 offset1:200
    v_mfma_f32_16x16x32_bf16 v[4:7], v[84:87], v[64:67], v[4:7]
    v_mfma_f32_16x16x32_bf16 v[16:19], v[80:83], v[68:71], v[16:19]
    ds_read_b128 v[96:99], v245 offset:32768
    ds_read_b64_tr_b16 v[112:113], v248 offset:36864
    s_add_u32 m0, s93, 2048
    v_mfma_f32_16x16x32_bf16 v[20:23], v[84:87], v[68:71], v[20:23]
    v_lshl_add_u32 v147, v147, 7, v242
    buffer_load_dwordx4 v147, s[20:23], 0 offen lds
    s_waitcnt lgkmcnt(4)
    v_mfma_f32_16x16x32_bf16 v[8:11], v[88:91], v[64:67], v[8:11]
    ds_read_b64_tr_b16 v[114:115], v248 offset:37376
    v_mfma_f32_16x16x32_bf16 v[24:27], v[88:91], v[68:71], v[24:27]
    ds_read_b128 v[100:103], v245 offset:34816
    v_mfma_f32_16x16x32_bf16 v[32:35], v[80:83], v[72:75], v[32:35]
    ds_read_b64_tr_b16 v[116:117], v249 offset:36864
    v_mfma_f32_16x16x32_bf16 v[36:39], v[84:87], v[72:75], v[36:39]
    ds_read_b64_tr_b16 v[118:119], v249 offset:37376
    v_mfma_f32_16x16x32_bf16 v[40:43], v[88:91], v[72:75], v[40:43]
    ds_read_b128 v[104:107], v245 offset:36864
    v_mfma_f32_16x16x32_bf16 v[12:15], v[92:95], v[64:67], v[12:15]
    ds_read_b64_tr_b16 v[120:121], v246 offset:36864
    v_mfma_f32_16x16x32_bf16 v[28:31], v[92:95], v[68:71], v[28:31]
    ds_read_b64_tr_b16 v[122:123], v246 offset:37376
    v_mfma_f32_16x16x32_bf16 v[44:47], v[92:95], v[72:75], v[44:47]
    ds_read_b128 v[108:111], v245 offset:38912
    v_mfma_f32_16x16x32_bf16 v[48:51], v[80:83], v[76:79], v[48:51]
    ds_read_b64_tr_b16 v[124:125], v247 offset:36864
    v_mfma_f32_16x16x32_bf16 v[52:55], v[84:87], v[76:79], v[52:55]
    ds_read_b64_tr_b16 v[126:127], v247 offset:37376
    v_mfma_f32_16x16x32_bf16 v[56:59], v[88:91], v[76:79], v[56:59]
    v_mfma_f32_16x16x32_bf16 v[60:63], v[92:95], v[76:79], v[60:63]
    s_waitcnt lgkmcnt(0)
    s_waitcnt vmcnt(2)
    s_barrier
    v_mfma_f32_16x16x32_bf16 v[48:51], v[112:115], v[108:111], v[48:51]
    ds_read_b128 v[64:67], v244 offset:0
    ds_read_b64_tr_b16 v[80:81], v248 offset:0
    v_mfma_f32_16x16x32_bf16 v[52:55], v[116:119], v[108:111], v[52:55]
    ds_read_b64_tr_b16 v[82:83], v248 offset:512
    v_mfma_f32_16x16x32_bf16 v[56:59], v[120:123], v[108:111], v[56:59]
    ds_read_b64_tr_b16 v[84:85], v249 offset:0
    ds_read_b64_tr_b16 v[86:87], v249 offset:512
    v_mfma_f32_16x16x32_bf16 v[60:63], v[124:127], v[108:111], v[60:63]
    ds_read_b64_tr_b16 v[88:89], v246 offset:0
    v_mfma_f32_16x16x32_bf16 v[32:35], v[112:115], v[104:107], v[32:35]
    ds_read_b64_tr_b16 v[90:91], v246 offset:512
    ds_read_b64_tr_b16 v[92:93], v247 offset:0
    v_mfma_f32_16x16x32_bf16 v[36:39], v[116:119], v[104:107], v[36:39]
    ds_read_b64_tr_b16 v[94:95], v247 offset:512
    v_mfma_f32_16x16x32_bf16 v[40:43], v[120:123], v[104:107], v[40:43]
    ds_read_b128 v[164:167], v245 offset:0
    ds_read_b64_tr_b16 v[172:173], v248 offset:4096
    v_mfma_f32_16x16x32_bf16 v[44:47], v[124:127], v[104:107], v[44:47]
    ds_read_b64_tr_b16 v[174:175], v248 offset:4608
    v_mfma_f32_16x16x32_bf16 v[16:19], v[112:115], v[100:103], v[16:19]
    ds_read_b64_tr_b16 v[176:177], v249 offset:4096
    ds_read_b64_tr_b16 v[178:179], v249 offset:4608
    v_mfma_f32_16x16x32_bf16 v[20:23], v[116:119], v[100:103], v[20:23]
    ds_read_b64_tr_b16 v[180:181], v246 offset:4096
    s_add_u32 m0, s93, 3072
    v_lshl_add_u32 v144, v144, 7, v241
    buffer_load_dwordx4 v144, s[20:23], 0 offen lds
    v_mfma_f32_16x16x32_bf16 v[24:27], v[120:123], v[100:103], v[24:27]
    s_waitcnt lgkmcnt(10)
    ds_read_b64_tr_b16 v[182:183], v246 offset:4608
    ds_read_b64_tr_b16 v[184:185], v247 offset:4096
    v_mfma_f32_16x16x32_bf16 v[28:31], v[124:127], v[100:103], v[28:31]
    ds_read_b64_tr_b16 v[186:187], v247 offset:4608
    v_mfma_f32_16x16x32_bf16 v[0:3], v[112:115], v[96:99], v[0:3]
    ds_read_b128 a[176:179], v150 offset:4096
    ds_read_b128 a[180:183], v151 offset:4096
    v_mfma_f32_16x16x32_bf16 v[4:7], v[116:119], v[96:99], v[4:7]
    s_waitcnt lgkmcnt(10)
    ds_read_b128 v[68:71], v244 offset:2048
    v_mfma_f32_16x16x32_bf16 v[8:11], v[120:123], v[96:99], v[8:11]
    ds_read_b128 v[168:171], v245 offset:2048
    ds_read_b128 v[72:75], v244 offset:4096
    v_mfma_f32_16x16x32_bf16 v[12:15], v[124:127], v[96:99], v[12:15]
    ds_read_b128 v[76:79], v244 offset:6144
    s_waitcnt lgkmcnt(4)
    v_mfma_f32_16x16x32_bf16 v[0:3], v[80:83], v[64:67], v[0:3]
    ds_read_b128 v[104:107], v245 offset:4096
    ds_read_b128 v[108:111], v245 offset:6144
    v_mfma_f32_16x16x32_bf16 v[4:7], v[84:87], v[64:67], v[4:7]
    v_mfma_f32_16x16x32_bf16 v[8:11], v[88:91], v[64:67], v[8:11]
    s_add_u32 m0, s93, 4096
    v_lshl_add_u32 v145, v145, 7, v242
    buffer_load_dwordx4 v145, s[20:23], 0 offen lds
    v_bfe_u32 v144, v240, 1, 1
    v_lshrrev_b32 v145, 4, v240
    v_xor_b32 v144, v144, v145
    v_and_b32 v145, 3, v240
    v_mfma_f32_16x16x32_bf16 v[12:15], v[92:95], v[64:67], v[12:15]
    v_mfma_f32_16x16x32_bf16 v[0:3], v[172:175], v[164:167], v[0:3]
    v_lshlrev_b32 v145, 7, v145
    v_lshl_add_u32 v144, v144, 4, v145
    v_add_u32 v144, s93, v144
    v_xor_b32 v145, 32, v144
    v_mfma_f32_16x16x32_bf16 v[4:7], v[176:179], v[164:167], v[4:7]
    v_mfma_f32_16x16x32_bf16 v[8:11], v[180:183], v[164:167], v[8:11]
    v_xor_b32 v146, 64, v144
    v_xor_b32 v147, 96, v144
    s_mov_b32 s94, 0
    v_mfma_f32_16x16x32_bf16 v[12:15], v[184:187], v[164:167], v[12:15]
    s_waitcnt lgkmcnt(5)
    v_mfma_f32_16x16x32_bf16 v[16:19], v[80:83], v[68:71], v[16:19]
    v_mfma_f32_16x16x32_bf16 v[20:23], v[84:87], v[68:71], v[20:23]
    v_cvt_pk_bf16_f32 v0, v0, v1
    v_cvt_pk_bf16_f32 v1, v2, v3
    v_mfma_f32_16x16x32_bf16 v[24:27], v[88:91], v[68:71], v[24:27]
    v_cvt_pk_bf16_f32 v2, v4, v5
    v_cvt_pk_bf16_f32 v3, v6, v7
    v_mfma_f32_16x16x32_bf16 v[28:31], v[92:95], v[68:71], v[28:31]
    buffer_store_dwordx4 v[0:3], v233, s[40:43], s88 offen offset:0 sc1
    s_waitcnt lgkmcnt(4)
    v_mfma_f32_16x16x32_bf16 v[16:19], v[172:175], v[168:171], v[16:19]
    v_cvt_pk_bf16_f32 v4, v8, v9
    v_cvt_pk_bf16_f32 v5, v10, v11
    v_mfma_f32_16x16x32_bf16 v[20:23], v[176:179], v[168:171], v[20:23]
    v_cvt_pk_bf16_f32 v6, v12, v13
    v_cvt_pk_bf16_f32 v7, v14, v15
    v_mfma_f32_16x16x32_bf16 v[24:27], v[180:183], v[168:171], v[24:27]
    buffer_store_dwordx4 v[4:7], v233, s[40:43], s88 offen offset:1024 sc1
    v_mfma_f32_16x16x32_bf16 v[28:31], v[184:187], v[168:171], v[28:31]
    s_waitcnt lgkmcnt(3)
    v_mfma_f32_16x16x32_bf16 v[32:35], v[80:83], v[72:75], v[32:35]
    s_waitcnt vmcnt(4)
    ds_read_b128 a[184:187], v148 offset:1024
    ds_read_b128 a[188:191], v149 offset:1024
    v_mfma_f32_16x16x32_bf16 v[36:39], v[84:87], v[72:75], v[36:39]
    v_cvt_pk_bf16_f32 v16, v16, v17
    v_cvt_pk_bf16_f32 v17, v18, v19
    v_mfma_f32_16x16x32_bf16 v[40:43], v[88:91], v[72:75], v[40:43]
    v_cvt_pk_bf16_f32 v18, v20, v21
    v_cvt_pk_bf16_f32 v19, v22, v23
    ds_read_b128 v[136:139], v154 offset:22528
    ds_read_b128 v[140:143], v154 offset:23552
    ds_read_b128 v[128:131], v154 offset:24576
    v_mfma_f32_16x16x32_bf16 v[44:47], v[92:95], v[72:75], v[44:47]
    buffer_store_dwordx4 v[16:19], v224, s[40:43], s88 offen offset:0 sc1
    s_waitcnt lgkmcnt(6)
    v_mfma_f32_16x16x32_bf16 v[32:35], v[172:175], v[104:107], v[32:35]
    v_cvt_pk_bf16_f32 v20, v24, v25
    v_cvt_pk_bf16_f32 v21, v26, v27
    v_mfma_f32_16x16x32_bf16 v[36:39], v[176:179], v[104:107], v[36:39]
    v_cvt_pk_bf16_f32 v22, v28, v29
    v_cvt_pk_bf16_f32 v23, v30, v31
    v_mfma_f32_16x16x32_bf16 v[40:43], v[180:183], v[104:107], v[40:43]
    buffer_store_dwordx4 v[20:23], v224, s[40:43], s88 offen offset:1024 sc1
    v_mfma_f32_16x16x32_bf16 v[44:47], v[184:187], v[104:107], v[44:47]
    v_mfma_f32_16x16x32_bf16 v[48:51], v[80:83], v[76:79], v[48:51]
    v_mfma_f32_16x16x32_bf16 v[52:55], v[84:87], v[76:79], v[52:55]
    v_cvt_pk_bf16_f32 v32, v32, v33
    v_cvt_pk_bf16_f32 v33, v34, v35
    v_mfma_f32_16x16x32_bf16 v[56:59], v[88:91], v[76:79], v[56:59]
    v_cvt_pk_bf16_f32 v34, v36, v37
    v_cvt_pk_bf16_f32 v35, v38, v39
    v_mfma_f32_16x16x32_bf16 v[60:63], v[92:95], v[76:79], v[60:63]
    buffer_store_dwordx4 v[32:35], v233, s[40:43], s89 offen offset:0 sc1
    s_waitcnt lgkmcnt(5)
    v_mfma_f32_16x16x32_bf16 v[48:51], v[172:175], v[108:111], v[48:51]
    v_cvt_pk_bf16_f32 v36, v40, v41
    v_cvt_pk_bf16_f32 v37, v42, v43
    v_mfma_f32_16x16x32_bf16 v[52:55], v[176:179], v[108:111], v[52:55]
    v_cvt_pk_bf16_f32 v38, v44, v45
    v_cvt_pk_bf16_f32 v39, v46, v47
    v_mfma_f32_16x16x32_bf16 v[56:59], v[180:183], v[108:111], v[56:59]
    buffer_store_dwordx4 v[36:39], v233, s[40:43], s89 offen offset:1024 sc1
    v_mfma_f32_16x16x32_bf16 v[60:63], v[184:187], v[108:111], v[60:63]
    v_cvt_pk_bf16_f32 v48, v48, v49
    v_cvt_pk_bf16_f32 v49, v50, v51
    s_nop 0
    v_cvt_pk_bf16_f32 v50, v52, v53
    v_cvt_pk_bf16_f32 v51, v54, v55
    s_nop 0
    v_cvt_pk_bf16_f32 v52, v56, v57
    v_cvt_pk_bf16_f32 v53, v58, v59
    v_cvt_pk_bf16_f32 v54, v60, v61
    v_cvt_pk_bf16_f32 v55, v62, v63
    s_mov_b64 exec, s[12:13]
    buffer_store_dwordx4 v[48:51], v224, s[40:43], s89 offen offset:0 sc1
    buffer_store_dwordx4 v[52:55], v224, s[40:43], s89 offen offset:1024 sc1
    s_not_b64 exec, exec
    ds_write_b128 v252, v[48:51]
    ds_write_b128 v252, v[52:55] offset:512
    s_mov_b64 exec, -1
    v_mfma_f32_16x16x32_bf16 v[64:67], a[0:3], a[96:99], 0
    v_mfma_f32_16x16x32_bf16 v[68:71], a[8:11], a[104:107], 0
    v_mfma_f32_16x16x32_bf16 v[72:75], a[16:19], a[112:115], 0
    v_mfma_f32_16x16x32_bf16 v[76:79], a[24:27], a[120:123], 0
    v_mfma_f32_16x16x32_bf16 v[64:67], a[4:7], a[100:103], v[64:67]
    v_mfma_f32_16x16x32_bf16 v[68:71], a[12:15], a[108:111], v[68:71]
    v_mfma_f32_16x16x32_bf16 v[72:75], a[20:23], a[116:119], v[72:75]
    v_mfma_f32_16x16x32_bf16 v[76:79], a[28:31], a[124:127], v[76:79]
    ds_read_b128 v[132:135], v154 offset:25600
    s_waitcnt lgkmcnt(5)
    v_mfma_f32_16x16x32_bf16 v[80:83], a[32:35], a[96:99], 0
    s_nop 1
    v_mul_f32 v120, v64, v136
    v_mul_f32 v121, v65, v137
    v_mfma_f32_16x16x32_bf16 v[84:87], a[40:43], a[104:107], 0
    v_fmac_f32 v120, v66, v138
    v_fmac_f32 v121, v67, v139
    v_mfma_f32_16x16x32_bf16 v[88:91], a[48:51], a[112:115], 0
    v_mul_f32 v122, v68, v136
    v_mul_f32 v123, v69, v137
    v_mfma_f32_16x16x32_bf16 v[92:95], a[56:59], a[120:123], 0
    v_fmac_f32 v122, v70, v138
    v_fmac_f32 v123, v71, v139
    v_mfma_f32_16x16x32_bf16 v[80:83], a[36:39], a[100:103], v[80:83]
    v_mul_f32 v124, v72, v136
    v_mul_f32 v125, v73, v137
    v_mfma_f32_16x16x32_bf16 v[84:87], a[44:47], a[108:111], v[84:87]
    v_fmac_f32 v124, v74, v138
    v_fmac_f32 v125, v75, v139
    v_mfma_f32_16x16x32_bf16 v[88:91], a[52:55], a[116:119], v[88:91]
    v_mul_f32 v126, v76, v136
    v_mul_f32 v127, v77, v137
    v_mfma_f32_16x16x32_bf16 v[92:95], a[60:63], a[124:127], v[92:95]
    v_fmac_f32 v126, v78, v138
    v_fmac_f32 v127, v79, v139
    ds_read_b128 v[136:139], v154 offset:26624
    s_waitcnt lgkmcnt(5)
    v_mfma_f32_16x16x32_bf16 v[96:99], a[64:67], a[96:99], 0
    v_fmac_f32 v120, v80, v140
    v_fmac_f32 v121, v81, v141
    v_mfma_f32_16x16x32_bf16 v[100:103], a[72:75], a[104:107], 0
    v_fmac_f32 v120, v82, v142
    v_fmac_f32 v121, v83, v143
    v_mfma_f32_16x16x32_bf16 v[104:107], a[80:83], a[112:115], 0
    v_fmac_f32 v122, v84, v140
    v_fmac_f32 v123, v85, v141
    v_mfma_f32_16x16x32_bf16 v[108:111], a[88:91], a[120:123], 0
    v_fmac_f32 v122, v86, v142
    v_fmac_f32 v123, v87, v143
    v_mfma_f32_16x16x32_bf16 v[96:99], a[68:71], a[100:103], v[96:99]
    v_fmac_f32 v124, v88, v140
    v_fmac_f32 v125, v89, v141
    v_mfma_f32_16x16x32_bf16 v[100:103], a[76:79], a[108:111], v[100:103]
    v_fmac_f32 v124, v90, v142
    v_fmac_f32 v125, v91, v143
    v_mfma_f32_16x16x32_bf16 v[104:107], a[84:87], a[116:119], v[104:107]
    v_fmac_f32 v126, v92, v140
    v_fmac_f32 v127, v93, v141
    v_mfma_f32_16x16x32_bf16 v[108:111], a[92:95], a[124:127], v[108:111]
    v_fmac_f32 v126, v94, v142
    v_fmac_f32 v127, v95, v143
    ds_read_b128 v[140:143], v154 offset:27648
    s_waitcnt lgkmcnt(5)
    v_mfma_f32_16x16x32_bf16 v[64:67], a[96:99], a[96:99], 0
    v_fmac_f32 v120, v96, v128
    v_fmac_f32 v121, v97, v129
    v_mfma_f32_16x16x32_bf16 v[68:71], a[104:107], a[104:107], 0
    v_fmac_f32 v120, v98, v130
    v_fmac_f32 v121, v99, v131
    v_mfma_f32_16x16x32_bf16 v[72:75], a[112:115], a[112:115], 0
    v_fmac_f32 v122, v100, v128
    v_fmac_f32 v123, v101, v129
    v_mfma_f32_16x16x32_bf16 v[76:79], a[120:123], a[120:123], 0
    v_fmac_f32 v122, v102, v130
    v_fmac_f32 v123, v103, v131
    v_mfma_f32_16x16x32_bf16 v[64:67], a[100:103], a[100:103], v[64:67]
    v_fmac_f32 v124, v104, v128
    v_fmac_f32 v125, v105, v129
    v_mfma_f32_16x16x32_bf16 v[68:71], a[108:111], a[108:111], v[68:71]
    v_fmac_f32 v124, v106, v130
    v_fmac_f32 v125, v107, v131
    v_mfma_f32_16x16x32_bf16 v[72:75], a[116:119], a[116:119], v[72:75]
    v_fmac_f32 v126, v108, v128
    v_fmac_f32 v127, v109, v129
    v_mfma_f32_16x16x32_bf16 v[76:79], a[124:127], a[124:127], v[76:79]
    v_fmac_f32 v126, v110, v130
    v_fmac_f32 v127, v111, v131
    ds_read_b128 v[128:131], v154 offset:28672
    s_waitcnt lgkmcnt(3)
    v_mfma_f32_16x16x32_bf16 v[80:83], a[0:3], a[128:131], 0
    v_fmac_f32 v120, v64, v132
    v_fmac_f32 v121, v65, v133
    v_mfma_f32_16x16x32_bf16 v[84:87], a[8:11], a[136:139], 0
    v_fmac_f32 v120, v66, v134
    v_fmac_f32 v121, v67, v135
    v_mfma_f32_16x16x32_bf16 v[88:91], a[16:19], a[144:147], 0
    v_fmac_f32 v122, v68, v132
    v_fmac_f32 v123, v69, v133
    v_mfma_f32_16x16x32_bf16 v[92:95], a[24:27], a[152:155], 0
    v_fmac_f32 v122, v70, v134
    v_fmac_f32 v123, v71, v135
    v_mfma_f32_16x16x32_bf16 v[80:83], a[4:7], a[132:135], v[80:83]
    v_fmac_f32 v124, v72, v132
    v_fmac_f32 v125, v73, v133
    v_mfma_f32_16x16x32_bf16 v[84:87], a[12:15], a[140:143], v[84:87]
    v_fmac_f32 v124, v74, v134
    v_fmac_f32 v125, v75, v135
    v_mfma_f32_16x16x32_bf16 v[88:91], a[20:23], a[148:151], v[88:91]
    v_fmac_f32 v126, v76, v132
    v_fmac_f32 v127, v77, v133
    v_mfma_f32_16x16x32_bf16 v[92:95], a[28:31], a[156:159], v[92:95]
    v_fmac_f32 v126, v78, v134
    v_fmac_f32 v127, v79, v135
    ds_read_b128 v[132:135], v154 offset:29696
    s_waitcnt lgkmcnt(3)
    v_mfma_f32_16x16x32_bf16 v[96:99], a[32:35], a[128:131], 0
    v_fmac_f32 v120, v80, v136
    v_fmac_f32 v121, v81, v137
    v_mfma_f32_16x16x32_bf16 v[100:103], a[40:43], a[136:139], 0
    v_fmac_f32 v120, v82, v138
    v_fmac_f32 v121, v83, v139
    v_mfma_f32_16x16x32_bf16 v[104:107], a[48:51], a[144:147], 0
    v_fmac_f32 v122, v84, v136
    v_fmac_f32 v123, v85, v137
    v_mfma_f32_16x16x32_bf16 v[108:111], a[56:59], a[152:155], 0
    v_fmac_f32 v122, v86, v138
    v_fmac_f32 v123, v87, v139
    v_mfma_f32_16x16x32_bf16 v[96:99], a[36:39], a[132:135], v[96:99]
    v_fmac_f32 v124, v88, v136
    v_fmac_f32 v125, v89, v137
    v_mfma_f32_16x16x32_bf16 v[100:103], a[44:47], a[140:143], v[100:103]
    v_fmac_f32 v124, v90, v138
    v_fmac_f32 v125, v91, v139
    v_mfma_f32_16x16x32_bf16 v[104:107], a[52:55], a[148:151], v[104:107]
    v_fmac_f32 v126, v92, v136
    v_fmac_f32 v127, v93, v137
    v_mfma_f32_16x16x32_bf16 v[108:111], a[60:63], a[156:159], v[108:111]
    v_fmac_f32 v126, v94, v138
    v_fmac_f32 v127, v95, v139
    ds_read_b128 v[136:139], v154 offset:30720
    s_waitcnt vmcnt(0)
    s_mov_b64 exec, 15
    buffer_store_dword v235, v227, s[40:43], s95 offen sc1
    s_mov_b64 exec, -1
    ds_read_b128 a[192:195], v144 offset:3072
    ds_read_b128 a[196:199], v146 offset:3072
    ds_read_b128 a[200:203], v145 offset:3584
    ds_read_b128 a[204:207], v147 offset:3584
    s_waitcnt lgkmcnt(7)
    v_mfma_f32_16x16x32_bf16 v[64:67], a[64:67], a[128:131], 0
    v_fmac_f32 v120, v96, v140
    v_fmac_f32 v121, v97, v141
    v_mfma_f32_16x16x32_bf16 v[68:71], a[72:75], a[136:139], 0
    v_fmac_f32 v120, v98, v142
    v_fmac_f32 v121, v99, v143
    v_mfma_f32_16x16x32_bf16 v[72:75], a[80:83], a[144:147], 0
    v_fmac_f32 v122, v100, v140
    v_fmac_f32 v123, v101, v141
    v_mfma_f32_16x16x32_bf16 v[76:79], a[88:91], a[152:155], 0
    v_fmac_f32 v122, v102, v142
    v_fmac_f32 v123, v103, v143
    v_mfma_f32_16x16x32_bf16 v[64:67], a[68:71], a[132:135], v[64:67]
    v_fmac_f32 v124, v104, v140
    v_fmac_f32 v125, v105, v141
    v_mfma_f32_16x16x32_bf16 v[68:71], a[76:79], a[140:143], v[68:71]
    v_fmac_f32 v124, v106, v142
    v_fmac_f32 v125, v107, v143
    v_mfma_f32_16x16x32_bf16 v[72:75], a[84:87], a[148:151], v[72:75]
    v_fmac_f32 v126, v108, v140
    v_fmac_f32 v127, v109, v141
    v_mfma_f32_16x16x32_bf16 v[76:79], a[92:95], a[156:159], v[76:79]
    v_fmac_f32 v126, v110, v142
    v_fmac_f32 v127, v111, v143
    ds_read_b128 v[140:143], v154 offset:31744
    ds_read_b128 a[208:211], v146 offset:4096
    ds_read_b128 a[212:215], v144 offset:4096
    ds_read_b128 a[216:219], v147 offset:4608
    ds_read_b128 a[220:223], v145 offset:4608
    s_waitcnt lgkmcnt(11)
    v_mfma_f32_16x16x32_bf16 v[80:83], a[96:99], a[128:131], 0
    v_fmac_f32 v120, v64, v128
    v_fmac_f32 v121, v65, v129
    v_mfma_f32_16x16x32_bf16 v[84:87], a[104:107], a[136:139], 0
    v_fmac_f32 v120, v66, v130
    v_fmac_f32 v121, v67, v131
    v_mfma_f32_16x16x32_bf16 v[88:91], a[112:115], a[144:147], 0
    v_fmac_f32 v122, v68, v128
    v_fmac_f32 v123, v69, v129
    v_mfma_f32_16x16x32_bf16 v[92:95], a[120:123], a[152:155], 0
    v_fmac_f32 v122, v70, v130
    v_fmac_f32 v123, v71, v131
    v_mfma_f32_16x16x32_bf16 v[80:83], a[100:103], a[132:135], v[80:83]
    v_fmac_f32 v124, v72, v128
    v_fmac_f32 v125, v73, v129
    v_mfma_f32_16x16x32_bf16 v[84:87], a[108:111], a[140:143], v[84:87]
    v_fmac_f32 v124, v74, v130
    v_fmac_f32 v125, v75, v131
    v_mfma_f32_16x16x32_bf16 v[88:91], a[116:119], a[148:151], v[88:91]
    v_fmac_f32 v126, v76, v128
    v_fmac_f32 v127, v77, v129
    v_mfma_f32_16x16x32_bf16 v[92:95], a[124:127], a[156:159], v[92:95]
    v_fmac_f32 v126, v78, v130
    v_fmac_f32 v127, v79, v131
    ds_read_b128 v[128:131], v154 offset:32768
    s_waitcnt lgkmcnt(11)
    v_mfma_f32_16x16x32_bf16 v[96:99], a[128:131], a[128:131], 0
    v_fmac_f32 v120, v80, v132
    v_fmac_f32 v121, v81, v133
    v_mfma_f32_16x16x32_bf16 v[100:103], a[136:139], a[136:139], 0
    v_fmac_f32 v120, v82, v134
    v_fmac_f32 v121, v83, v135
    v_mfma_f32_16x16x32_bf16 v[104:107], a[144:147], a[144:147], 0
    v_fmac_f32 v122, v84, v132
    v_fmac_f32 v123, v85, v133
    v_mfma_f32_16x16x32_bf16 v[108:111], a[152:155], a[152:155], 0
    v_fmac_f32 v122, v86, v134
    v_fmac_f32 v123, v87, v135
    v_mfma_f32_16x16x32_bf16 v[96:99], a[132:135], a[132:135], v[96:99]
    v_fmac_f32 v124, v88, v132
    v_fmac_f32 v125, v89, v133
    v_mfma_f32_16x16x32_bf16 v[100:103], a[140:143], a[140:143], v[100:103]
    v_fmac_f32 v124, v90, v134
    v_fmac_f32 v125, v91, v135
    v_mfma_f32_16x16x32_bf16 v[104:107], a[148:151], a[148:151], v[104:107]
    v_fmac_f32 v126, v92, v132
    v_fmac_f32 v127, v93, v133
    v_mfma_f32_16x16x32_bf16 v[108:111], a[156:159], a[156:159], v[108:111]
    v_fmac_f32 v126, v94, v134
    v_fmac_f32 v127, v95, v135
    ds_read_b128 v[132:135], v154 offset:33792
    s_waitcnt lgkmcnt(11)
    v_mfma_f32_16x16x32_bf16 v[64:67], a[0:3], a[160:163], 0
    v_fmac_f32 v120, v96, v136
    v_fmac_f32 v121, v97, v137
    v_mfma_f32_16x16x32_bf16 v[68:71], a[8:11], a[168:171], 0
    v_fmac_f32 v120, v98, v138
    v_fmac_f32 v121, v99, v139
    v_mfma_f32_16x16x32_bf16 v[72:75], a[16:19], a[176:179], 0
    v_fmac_f32 v122, v100, v136
    v_fmac_f32 v123, v101, v137
    v_mfma_f32_16x16x32_bf16 v[76:79], a[24:27], a[184:187], 0
    v_fmac_f32 v122, v102, v138
    v_fmac_f32 v123, v103, v139
    v_mfma_f32_16x16x32_bf16 v[64:67], a[4:7], a[164:167], v[64:67]
    v_fmac_f32 v124, v104, v136
    v_fmac_f32 v125, v105, v137
    v_mfma_f32_16x16x32_bf16 v[68:71], a[12:15], a[172:175], v[68:71]
    v_fmac_f32 v124, v106, v138
    v_fmac_f32 v125, v107, v139
    v_mfma_f32_16x16x32_bf16 v[72:75], a[20:23], a[180:183], v[72:75]
    v_fmac_f32 v126, v108, v136
    v_fmac_f32 v127, v109, v137
    v_mfma_f32_16x16x32_bf16 v[76:79], a[28:31], a[188:191], v[76:79]
    v_fmac_f32 v126, v110, v138
    v_fmac_f32 v127, v111, v139
    ds_read_b128 v[136:139], v154 offset:34816
    s_waitcnt lgkmcnt(7)
    v_mfma_f32_16x16x32_bf16 v[80:83], a[32:35], a[160:163], 0
    v_fmac_f32 v120, v64, v140
    v_fmac_f32 v121, v65, v141
    v_mfma_f32_16x16x32_bf16 v[84:87], a[40:43], a[168:171], 0
    v_fmac_f32 v120, v66, v142
    v_fmac_f32 v121, v67, v143
    v_mfma_f32_16x16x32_bf16 v[88:91], a[48:51], a[176:179], 0
    v_fmac_f32 v122, v68, v140
    v_fmac_f32 v123, v69, v141
    v_mfma_f32_16x16x32_bf16 v[92:95], a[56:59], a[184:187], 0
    v_fmac_f32 v122, v70, v142
    v_fmac_f32 v123, v71, v143
    v_mfma_f32_16x16x32_bf16 v[80:83], a[36:39], a[164:167], v[80:83]
    v_fmac_f32 v124, v72, v140
    v_fmac_f32 v125, v73, v141
    v_mfma_f32_16x16x32_bf16 v[84:87], a[44:47], a[172:175], v[84:87]
    v_fmac_f32 v124, v74, v142
    v_fmac_f32 v125, v75, v143
    v_mfma_f32_16x16x32_bf16 v[88:91], a[52:55], a[180:183], v[88:91]
    v_fmac_f32 v126, v76, v140
    v_fmac_f32 v127, v77, v141
    v_mfma_f32_16x16x32_bf16 v[92:95], a[60:63], a[188:191], v[92:95]
    v_fmac_f32 v126, v78, v142
    v_fmac_f32 v127, v79, v143
    ds_read_b128 v[140:143], v154 offset:35840
    s_waitcnt lgkmcnt(3)
    v_mfma_f32_16x16x32_bf16 v[96:99], a[64:67], a[160:163], 0
    v_fmac_f32 v120, v80, v128
    v_fmac_f32 v121, v81, v129
    v_mfma_f32_16x16x32_bf16 v[100:103], a[72:75], a[168:171], 0
    v_fmac_f32 v120, v82, v130
    v_fmac_f32 v121, v83, v131
    v_mfma_f32_16x16x32_bf16 v[104:107], a[80:83], a[176:179], 0
    v_fmac_f32 v122, v84, v128
    v_fmac_f32 v123, v85, v129
    v_mfma_f32_16x16x32_bf16 v[108:111], a[88:91], a[184:187], 0
    v_fmac_f32 v122, v86, v130
    v_fmac_f32 v123, v87, v131
    v_mfma_f32_16x16x32_bf16 v[96:99], a[68:71], a[164:167], v[96:99]
    v_fmac_f32 v124, v88, v128
    v_fmac_f32 v125, v89, v129
    v_mfma_f32_16x16x32_bf16 v[100:103], a[76:79], a[172:175], v[100:103]
    v_fmac_f32 v124, v90, v130
    v_fmac_f32 v125, v91, v131
    v_mfma_f32_16x16x32_bf16 v[104:107], a[84:87], a[180:183], v[104:107]
    v_fmac_f32 v126, v92, v128
    v_fmac_f32 v127, v93, v129
    v_mfma_f32_16x16x32_bf16 v[108:111], a[92:95], a[188:191], v[108:111]
    v_fmac_f32 v126, v94, v130
    v_fmac_f32 v127, v95, v131
    ds_read_b128 v[128:131], v154 offset:0
    buffer_load_dword v112, v243, s[40:43], s96 offen sc1
    s_waitcnt lgkmcnt(3)
    v_mfma_f32_16x16x32_bf16 v[64:67], a[96:99], a[160:163], 0
    v_fmac_f32 v120, v96, v132
    v_fmac_f32 v121, v97, v133
    v_mfma_f32_16x16x32_bf16 v[68:71], a[104:107], a[168:171], 0
    v_fmac_f32 v120, v98, v134
    v_fmac_f32 v121, v99, v135
    v_mfma_f32_16x16x32_bf16 v[72:75], a[112:115], a[176:179], 0
    v_fmac_f32 v122, v100, v132
    v_fmac_f32 v123, v101, v133
    v_mfma_f32_16x16x32_bf16 v[76:79], a[120:123], a[184:187], 0
    v_fmac_f32 v122, v102, v134
    v_fmac_f32 v123, v103, v135
    v_mfma_f32_16x16x32_bf16 v[64:67], a[100:103], a[164:167], v[64:67]
    v_fmac_f32 v124, v104, v132
    v_fmac_f32 v125, v105, v133
    v_mfma_f32_16x16x32_bf16 v[68:71], a[108:111], a[172:175], v[68:71]
    v_fmac_f32 v124, v106, v134
    v_fmac_f32 v125, v107, v135
    v_mfma_f32_16x16x32_bf16 v[72:75], a[116:119], a[180:183], v[72:75]
    v_fmac_f32 v126, v108, v132
    v_fmac_f32 v127, v109, v133
    v_mfma_f32_16x16x32_bf16 v[76:79], a[124:127], a[188:191], v[76:79]
    v_fmac_f32 v126, v110, v134
    v_fmac_f32 v127, v111, v135
    ds_read_b128 v[132:135], v154 offset:1024
    s_waitcnt lgkmcnt(3)
    v_mfma_f32_16x16x32_bf16 v[80:83], a[128:131], a[160:163], 0
    v_fmac_f32 v120, v64, v136
    v_fmac_f32 v121, v65, v137
    v_mfma_f32_16x16x32_bf16 v[84:87], a[136:139], a[168:171], 0
    v_fmac_f32 v120, v66, v138
    v_fmac_f32 v121, v67, v139
    v_mfma_f32_16x16x32_bf16 v[88:91], a[144:147], a[176:179], 0
    v_fmac_f32 v122, v68, v136
    v_fmac_f32 v123, v69, v137
    v_mfma_f32_16x16x32_bf16 v[92:95], a[152:155], a[184:187], 0
    v_fmac_f32 v122, v70, v138
    v_fmac_f32 v123, v71, v139
    v_mfma_f32_16x16x32_bf16 v[80:83], a[132:135], a[164:167], v[80:83]
    v_fmac_f32 v124, v72, v136
    v_fmac_f32 v125, v73, v137
    v_mfma_f32_16x16x32_bf16 v[84:87], a[140:143], a[172:175], v[84:87]
    v_fmac_f32 v124, v74, v138
    v_fmac_f32 v125, v75, v139
    v_mfma_f32_16x16x32_bf16 v[88:91], a[148:151], a[180:183], v[88:91]
    v_fmac_f32 v126, v76, v136
    v_fmac_f32 v127, v77, v137
    v_mfma_f32_16x16x32_bf16 v[92:95], a[156:159], a[188:191], v[92:95]
    v_fmac_f32 v126, v78, v138
    v_fmac_f32 v127, v79, v139
    ds_read_b128 v[136:139], v154 offset:2048
    s_waitcnt lgkmcnt(3)
    v_mfma_f32_16x16x32_bf16 v[96:99], a[160:163], a[160:163], 0
    v_fmac_f32 v120, v80, v140
    v_fmac_f32 v121, v81, v141
    v_mfma_f32_16x16x32_bf16 v[100:103], a[168:171], a[168:171], 0
    v_fmac_f32 v120, v82, v142
    v_fmac_f32 v121, v83, v143
    v_mfma_f32_16x16x32_bf16 v[104:107], a[176:179], a[176:179], 0
    v_fmac_f32 v122, v84, v140
    v_fmac_f32 v123, v85, v141
    v_mfma_f32_16x16x32_bf16 v[108:111], a[184:187], a[184:187], 0
    v_fmac_f32 v122, v86, v142
    v_fmac_f32 v123, v87, v143
    v_mfma_f32_16x16x32_bf16 v[96:99], a[164:167], a[164:167], v[96:99]
    v_fmac_f32 v124, v88, v140
    v_fmac_f32 v125, v89, v141
    v_mfma_f32_16x16x32_bf16 v[100:103], a[172:175], a[172:175], v[100:103]
    v_fmac_f32 v124, v90, v142
    v_fmac_f32 v125, v91, v143
    v_mfma_f32_16x16x32_bf16 v[104:107], a[180:183], a[180:183], v[104:107]
    v_fmac_f32 v126, v92, v140
    v_fmac_f32 v127, v93, v141
    v_mfma_f32_16x16x32_bf16 v[108:111], a[188:191], a[188:191], v[108:111]
    v_fmac_f32 v126, v94, v142
    v_fmac_f32 v127, v95, v143
    ds_read_b128 v[140:143], v154 offset:3072
    s_waitcnt lgkmcnt(3)
    v_mfma_f32_16x16x32_bf16 v[64:67], a[0:3], a[192:195], 0
    v_fmac_f32 v120, v96, v128
    v_fmac_f32 v121, v97, v129
    v_mfma_f32_16x16x32_bf16 v[68:71], a[8:11], a[200:203], 0
    v_fmac_f32 v120, v98, v130
    v_fmac_f32 v121, v99, v131
    v_mfma_f32_16x16x32_bf16 v[72:75], a[16:19], a[208:211], 0
    v_fmac_f32 v122, v100, v128
    v_fmac_f32 v123, v101, v129
    v_mfma_f32_16x16x32_bf16 v[76:79], a[24:27], a[216:219], 0
    v_fmac_f32 v122, v102, v130
    v_fmac_f32 v123, v103, v131
    v_mfma_f32_16x16x32_bf16 v[64:67], a[4:7], a[196:199], v[64:67]
    v_fmac_f32 v124, v104, v128
    v_fmac_f32 v125, v105, v129
    v_mfma_f32_16x16x32_bf16 v[68:71], a[12:15], a[204:207], v[68:71]
    v_fmac_f32 v124, v106, v130
    v_fmac_f32 v125, v107, v131
    v_mfma_f32_16x16x32_bf16 v[72:75], a[20:23], a[212:215], v[72:75]
    v_fmac_f32 v126, v108, v128
    v_fmac_f32 v127, v109, v129
    v_mfma_f32_16x16x32_bf16 v[76:79], a[28:31], a[220:223], v[76:79]
    v_fmac_f32 v126, v110, v130
    v_fmac_f32 v127, v111, v131
    ds_read_b128 v[128:131], v154 offset:4096
    s_waitcnt lgkmcnt(3)
    v_mfma_f32_16x16x32_bf16 v[80:83], a[32:35], a[192:195], 0
    v_fmac_f32 v120, v64, v132
    v_fmac_f32 v121, v65, v133
    v_mfma_f32_16x16x32_bf16 v[84:87], a[40:43], a[200:203], 0
    v_fmac_f32 v120, v66, v134
    v_fmac_f32 v121, v67, v135
    v_mfma_f32_16x16x32_bf16 v[88:91], a[48:51], a[208:211], 0
    v_fmac_f32 v122, v68, v132
    v_fmac_f32 v123, v69, v133
    v_mfma_f32_16x16x32_bf16 v[92:95], a[56:59], a[216:219], 0
    v_fmac_f32 v122, v70, v134
    v_fmac_f32 v123, v71, v135
    v_mfma_f32_16x16x32_bf16 v[80:83], a[36:39], a[196:199], v[80:83]
    v_fmac_f32 v124, v72, v132
    v_fmac_f32 v125, v73, v133
    v_mfma_f32_16x16x32_bf16 v[84:87], a[44:47], a[204:207], v[84:87]
    v_fmac_f32 v124, v74, v134
    v_fmac_f32 v125, v75, v135
    v_mfma_f32_16x16x32_bf16 v[88:91], a[52:55], a[212:215], v[88:91]
    v_fmac_f32 v126, v76, v132
    v_fmac_f32 v127, v77, v133
    v_mfma_f32_16x16x32_bf16 v[92:95], a[60:63], a[220:223], v[92:95]
    v_fmac_f32 v126, v78, v134
    v_fmac_f32 v127, v79, v135
    ds_read_b128 v[132:135], v154 offset:5120
    s_waitcnt lgkmcnt(3)
    v_mfma_f32_16x16x32_bf16 v[96:99], a[64:67], a[192:195], 0
    v_fmac_f32 v120, v80, v136
    v_fmac_f32 v121, v81, v137
    v_mfma_f32_16x16x32_bf16 v[100:103], a[72:75], a[200:203], 0
    v_fmac_f32 v120, v82, v138
    v_fmac_f32 v121, v83, v139
    v_mfma_f32_16x16x32_bf16 v[104:107], a[80:83], a[208:211], 0
    v_fmac_f32 v122, v84, v136
    v_fmac_f32 v123, v85, v137
    v_mfma_f32_16x16x32_bf16 v[108:111], a[88:91], a[216:219], 0
    v_fmac_f32 v122, v86, v138
    v_fmac_f32 v123, v87, v139
    v_mfma_f32_16x16x32_bf16 v[96:99], a[68:71], a[196:199], v[96:99]
    v_fmac_f32 v124, v88, v136
    v_fmac_f32 v125, v89, v137
    v_mfma_f32_16x16x32_bf16 v[100:103], a[76:79], a[204:207], v[100:103]
    v_fmac_f32 v124, v90, v138
    v_fmac_f32 v125, v91, v139
    v_mfma_f32_16x16x32_bf16 v[104:107], a[84:87], a[212:215], v[104:107]
    v_fmac_f32 v126, v92, v136
    v_fmac_f32 v127, v93, v137
    v_mfma_f32_16x16x32_bf16 v[108:111], a[92:95], a[220:223], v[108:111]
    v_fmac_f32 v126, v94, v138
    v_fmac_f32 v127, v95, v139
    ds_read_b128 v[136:139], v154 offset:6144
    s_waitcnt vmcnt(0)
    v_cmp_ne_u32 vcc, 1, v112
    s_cbranch_vccnz L_late0
    s_mov_b64 exec, s[14:15]
    buffer_load_dwordx4 v[8:11], v225, s[40:43], s90 offen offset:0 sc1
    buffer_load_dwordx4 v[12:15], v225, s[40:43], s90 offen offset:1024 sc1
    s_not_b64 exec, exec
    ds_read_b128 v[8:11], v253 offset:0
    ds_read_b128 v[12:15], v253 offset:512
    s_mov_b64 exec, -1
    buffer_load_dwordx4 v[24:27], v225, s[40:43], s90 offen offset:2048 sc1
    buffer_load_dwordx4 v[28:31], v225, s[40:43], s90 offen offset:3072 sc1
    buffer_load_dwordx4 v[40:43], v225, s[40:43], s91 offen offset:0 sc1
    buffer_load_dwordx4 v[44:47], v225, s[40:43], s91 offen offset:1024 sc1
    buffer_load_dwordx4 v[56:59], v225, s[40:43], s91 offen offset:2048 sc1
    buffer_load_dwordx4 v[60:63], v225, s[40:43], s91 offen offset:3072 sc1
    s_mov_b32 s94, 1
L_late0:
    s_waitcnt lgkmcnt(3)
    v_mfma_f32_16x16x32_bf16 v[64:67], a[96:99], a[192:195], 0
    v_fmac_f32 v120, v96, v140
    v_fmac_f32 v121, v97, v141
    v_mfma_f32_16x16x32_bf16 v[68:71], a[104:107], a[200:203], 0
    v_fmac_f32 v120, v98, v142
    v_fmac_f32 v121, v99, v143
    v_mfma_f32_16x16x32_bf16 v[72:75], a[112:115], a[208:211], 0
    v_fmac_f32 v122, v100, v140
    v_fmac_f32 v123, v101, v141
    v_mfma_f32_16x16x32_bf16 v[76:79], a[120:123], a[216:219], 0
    v_fmac_f32 v122, v102, v142
    v_fmac_f32 v123, v103, v143
    v_mfma_f32_16x16x32_bf16 v[64:67], a[100:103], a[196:199], v[64:67]
    v_fmac_f32 v124, v104, v140
    v_fmac_f32 v125, v105, v141
    v_mfma_f32_16x16x32_bf16 v[68:71], a[108:111], a[204:207], v[68:71]
    v_fmac_f32 v124, v106, v142
    v_fmac_f32 v125, v107, v143
    v_mfma_f32_16x16x32_bf16 v[72:75], a[116:119], a[212:215], v[72:75]
    v_fmac_f32 v126, v108, v140
    v_fmac_f32 v127, v109, v141
    v_mfma_f32_16x16x32_bf16 v[76:79], a[124:127], a[220:223], v[76:79]
    v_fmac_f32 v126, v110, v142
    v_fmac_f32 v127, v111, v143
    ds_read_b128 v[140:143], v154 offset:7168
    s_waitcnt lgkmcnt(3)
    v_mfma_f32_16x16x32_bf16 v[80:83], a[128:131], a[192:195], 0
    v_fmac_f32 v120, v64, v128
    v_fmac_f32 v121, v65, v129
    v_mfma_f32_16x16x32_bf16 v[84:87], a[136:139], a[200:203], 0
    v_fmac_f32 v120, v66, v130
    v_fmac_f32 v121, v67, v131
    v_mfma_f32_16x16x32_bf16 v[88:91], a[144:147], a[208:211], 0
    v_fmac_f32 v122, v68, v128
    v_fmac_f32 v123, v69, v129
    v_mfma_f32_16x16x32_bf16 v[92:95], a[152:155], a[216:219], 0
    v_fmac_f32 v122, v70, v130
    v_fmac_f32 v123, v71, v131
    v_mfma_f32_16x16x32_bf16 v[80:83], a[132:135], a[196:199], v[80:83]
    v_fmac_f32 v124, v72, v128
    v_fmac_f32 v125, v73, v129
    v_mfma_f32_16x16x32_bf16 v[84:87], a[140:143], a[204:207], v[84:87]
    v_fmac_f32 v124, v74, v130
    v_fmac_f32 v125, v75, v131
    v_mfma_f32_16x16x32_bf16 v[88:91], a[148:151], a[212:215], v[88:91]
    v_fmac_f32 v126, v76, v128
    v_fmac_f32 v127, v77, v129
    v_mfma_f32_16x16x32_bf16 v[92:95], a[156:159], a[220:223], v[92:95]
    v_fmac_f32 v126, v78, v130
    v_fmac_f32 v127, v79, v131
    s_waitcnt lgkmcnt(2)
    v_mfma_f32_16x16x32_bf16 v[96:99], a[160:163], a[192:195], 0
    v_fmac_f32 v120, v80, v132
    v_fmac_f32 v121, v81, v133
    v_mfma_f32_16x16x32_bf16 v[100:103], a[168:171], a[200:203], 0
    v_fmac_f32 v120, v82, v134
    v_fmac_f32 v121, v83, v135
    v_mfma_f32_16x16x32_bf16 v[104:107], a[176:179], a[208:211], 0
    v_fmac_f32 v122, v84, v132
    v_fmac_f32 v123, v85, v133
    v_mfma_f32_16x16x32_bf16 v[108:111], a[184:187], a[216:219], 0
    v_fmac_f32 v122, v86, v134
    v_fmac_f32 v123, v87, v135
    v_mfma_f32_16x16x32_bf16 v[96:99], a[164:167], a[196:199], v[96:99]
    v_fmac_f32 v124, v88, v132
    v_fmac_f32 v125, v89, v133
    v_mfma_f32_16x16x32_bf16 v[100:103], a[172:175], a[204:207], v[100:103]
    v_fmac_f32 v124, v90, v134
    v_fmac_f32 v125, v91, v135
    v_mfma_f32_16x16x32_bf16 v[104:107], a[180:183], a[212:215], v[104:107]
    v_fmac_f32 v126, v92, v132
    v_fmac_f32 v127, v93, v133
    v_mfma_f32_16x16x32_bf16 v[108:111], a[188:191], a[220:223], v[108:111]
    v_fmac_f32 v126, v94, v134
    v_fmac_f32 v127, v95, v135
    s_waitcnt lgkmcnt(1)
    v_mfma_f32_16x16x32_bf16 v[64:67], a[192:195], a[192:195], 0
    v_fmac_f32 v120, v96, v136
    v_fmac_f32 v121, v97, v137
    v_mfma_f32_16x16x32_bf16 v[68:71], a[200:203], a[200:203], 0
    v_fmac_f32 v120, v98, v138
    v_fmac_f32 v121, v99, v139
    v_mfma_f32_16x16x32_bf16 v[72:75], a[208:211], a[208:211], 0
    v_fmac_f32 v122, v100, v136
    v_fmac_f32 v123, v101, v137
    v_mfma_f32_16x16x32_bf16 v[76:79], a[216:219], a[216:219], 0
    v_fmac_f32 v122, v102, v138
    v_fmac_f32 v123, v103, v139
    v_mfma_f32_16x16x32_bf16 v[64:67], a[196:199], a[196:199], v[64:67]
    v_fmac_f32 v124, v104, v136
    v_fmac_f32 v125, v105, v137
    v_mfma_f32_16x16x32_bf16 v[68:71], a[204:207], a[204:207], v[68:71]
    v_fmac_f32 v124, v106, v138
    v_fmac_f32 v125, v107, v139
    v_mfma_f32_16x16x32_bf16 v[72:75], a[212:215], a[212:215], v[72:75]
    v_fmac_f32 v126, v108, v136
    v_fmac_f32 v127, v109, v137
    v_mfma_f32_16x16x32_bf16 v[76:79], a[220:223], a[220:223], v[76:79]
    v_fmac_f32 v126, v110, v138
    v_fmac_f32 v127, v111, v139
    s_waitcnt lgkmcnt(0)
    s_mov_b32 s4, 0xaaaaaaaa
    s_mov_b32 s5, 0xaaaaaaaa
    s_mov_b32 s6, 0xcccccccc
    s_mov_b32 s7, 0xcccccccc
    s_mov_b32 s70, 0xbdd2d3e8
    s_mov_b32 s71, 0xbdd2d3e8
    v_mov_b32 v144, 0xc0135761
    v_mov_b32 v145, 0xc0135761
    v_lshlrev_b32 v147, 1, v240
    s_lshl3_add_u32 s3, s57, s58
    s_lshl2_add_u32 s3, s3, s56
    s_lshl_b32 s3, s3, 3
    s_cmp_lg_u32 s94, 0
    s_cbranch_scc1 L_have
    s_mov_b32 s97, 0x10000
    buffer_load_dword v112, v243, s[40:43], s96 offen sc1
L_poll:
    buffer_load_dword v116, v243, s[40:43], s96 offen sc1
    s_waitcnt vmcnt(1)
    v_cmp_ne_u32 vcc, 1, v112
    s_cbranch_vccz L_go
    buffer_load_dword v112, v243, s[40:43], s96 offen sc1
    s_waitcnt vmcnt(1)
    v_cmp_ne_u32 vcc, 1, v116
    s_cbranch_vccz L_go
    s_sub_u32 s97, s97, 1
    s_cbranch_scc0 L_poll
L_go:
    s_mov_b64 exec, s[14:15]
    buffer_load_dwordx4 v[8:11], v225, s[40:43], s90 offen offset:0 sc1
    buffer_load_dwordx4 v[12:15], v225, s[40:43], s90 offen offset:1024 sc1
    s_not_b64 exec, exec
    ds_read_b128 v[8:11], v253 offset:0
    ds_read_b128 v[12:15], v253 offset:512
    s_mov_b64 exec, -1
    buffer_load_dwordx4 v[24:27], v225, s[40:43], s90 offen offset:2048 sc1
    buffer_load_dwordx4 v[28:31], v225, s[40:43], s90 offen offset:3072 sc1
    buffer_load_dwordx4 v[40:43], v225, s[40:43], s91 offen offset:0 sc1
    buffer_load_dwordx4 v[44:47], v225, s[40:43], s91 offen offset:1024 sc1
    buffer_load_dwordx4 v[56:59], v225, s[40:43], s91 offen offset:2048 sc1
    buffer_load_dwordx4 v[60:63], v225, s[40:43], s91 offen offset:3072 sc1
L_have:
    s_waitcnt lgkmcnt(0)
    s_waitcnt vmcnt(6)
    v_mfma_f32_16x16x32_bf16 v[192:195], a[228:231], v[8:11], v[192:195]
    v_fmac_f32 v120, v64, v140
    v_fmac_f32 v121, v65, v141
    v_mfma_f32_16x16x32_bf16 v[196:199], a[226:229], v[8:11], v[196:199]
    v_fmac_f32 v120, v66, v142
    v_fmac_f32 v121, v67, v143
    v_mfma_f32_16x16x32_bf16 v[200:203], a[228:231], v[12:15], v[200:203]
    v_fmac_f32 v122, v68, v140
    v_fmac_f32 v123, v69, v141
    v_mfma_f32_16x16x32_bf16 v[204:207], a[226:229], v[12:15], v[204:207]
    v_fmac_f32 v122, v70, v142
    v_fmac_f32 v123, v71, v143
    s_waitcnt vmcnt(4)
    v_mfma_f32_16x16x32_bf16 v[192:195], a[228:231], v[24:27], v[192:195]
    v_fmac_f32 v124, v72, v140
    v_fmac_f32 v125, v73, v141
    v_mfma_f32_16x16x32_bf16 v[196:199], a[226:229], v[24:27], v[196:199]
    v_fmac_f32 v124, v74, v142
    v_fmac_f32 v125, v75, v143
    v_mfma_f32_16x16x32_bf16 v[200:203], a[228:231], v[28:31], v[200:203]
    v_fmac_f32 v126, v76, v140
    v_fmac_f32 v127, v77, v141
    v_mfma_f32_16x16x32_bf16 v[204:207], a[226:229], v[28:31], v[204:207]
    v_fmac_f32 v126, v78, v142
    v_fmac_f32 v127, v79, v143
    s_waitcnt vmcnt(2)
    v_mfma_f32_16x16x32_bf16 v[192:195], a[228:231], v[40:43], v[192:195]
    v_add_f32 v120, v120, v121
    v_add_f32 v122, v122, v123
    v_mfma_f32_16x16x32_bf16 v[196:199], a[226:229], v[40:43], v[196:199]
    v_add_f32 v124, v124, v125
    v_add_f32 v126, v126, v127
    v_mfma_f32_16x16x32_bf16 v[200:203], a[228:231], v[44:47], v[200:203]
    v_add_f32 v120, v120, v160
    v_add_f32 v122, v122, v161
    v_mfma_f32_16x16x32_bf16 v[204:207], a[226:229], v[44:47], v[204:207]
    v_add_f32 v124, v124, v162
    v_add_f32 v126, v126, v163
    s_waitcnt vmcnt(0)
    v_mfma_f32_16x16x32_bf16 v[192:195], a[228:231], v[56:59], v[192:195]
    v_cndmask_b32 v121, v122, v120, s[4:5]
    v_cndmask_b32 v125, v126, v124, s[4:5]
    v_mfma_f32_16x16x32_bf16 v[196:199], a[226:229], v[56:59], v[196:199]
    v_cndmask_b32 v120, v120, v122, s[4:5]
    v_cndmask_b32 v124, v124, v126, s[4:5]
    v_mfma_f32_16x16x32_bf16 v[200:203], a[228:231], v[60:63], v[200:203]
    v_add_f32_dpp v120, v121, v120 quad_perm:[1,0,3,2] row_mask:0xf bank_mask:0xf
    v_add_f32_dpp v124, v125, v124 quad_perm:[1,0,3,2] row_mask:0xf bank_mask:0xf
    v_mfma_f32_16x16x32_bf16 v[204:207], a[226:229], v[60:63], v[204:207]
    v_cndmask_b32 v121, v124, v120, s[6:7]
    v_cndmask_b32 v150, v120, v124, s[6:7]
    s_nop 1
    v_add_f32_dpp v150, v121, v150 quad_perm:[2,3,0,1] row_mask:0xf bank_mask:0xf
    v_pk_mul_f32 v[64:65], v[192:193], v[192:193]
    v_pk_mul_f32 v[66:67], v[194:195], v[194:195]
    v_pk_mul_f32 v[68:69], v[196:197], v[196:197]
    v_pk_mul_f32 v[70:71], v[198:199], v[198:199]
    v_pk_mul_f32 v[72:73], v[200:201], v[200:201]
    v_pk_mul_f32 v[74:75], v[202:203], v[202:203]
    v_pk_mul_f32 v[76:77], v[204:205], v[204:205]
    v_pk_mul_f32 v[78:79], v[206:207], v[206:207]
    v_pk_fma_f32 v[64:65], v[64:65], s[70:71], v[144:145]
    v_pk_fma_f32 v[66:67], v[66:67], s[70:71], v[144:145]
    v_pk_fma_f32 v[68:69], v[68:69], s[70:71], v[144:145]
    v_pk_fma_f32 v[70:71], v[70:71], s[70:71], v[144:145]
    v_pk_fma_f32 v[72:73], v[72:73], s[70:71], v[144:145]
    v_pk_fma_f32 v[74:75], v[74:75], s[70:71], v[144:145]
    v_pk_fma_f32 v[76:77], v[76:77], s[70:71], v[144:145]
    v_pk_fma_f32 v[78:79], v[78:79], s[70:71], v[144:145]
    v_pk_mul_f32 v[64:65], v[64:65], v[192:193]
    v_pk_mul_f32 v[66:67], v[66:67], v[194:195]
    v_pk_mul_f32 v[68:69], v[68:69], v[196:197]
    v_pk_mul_f32 v[70:71], v[70:71], v[198:199]
    v_pk_mul_f32 v[72:73], v[72:73], v[200:201]
    v_pk_mul_f32 v[74:75], v[74:75], v[202:203]
    v_pk_mul_f32 v[76:77], v[76:77], v[204:205]
    v_pk_mul_f32 v[78:79], v[78:79], v[206:207]
    v_exp_f32 v64, v64
    v_exp_f32 v65, v65
    v_exp_f32 v66, v66
    v_exp_f32 v67, v67
    v_exp_f32 v68, v68
    v_exp_f32 v69, v69
    v_exp_f32 v70, v70
    v_exp_f32 v71, v71
    v_exp_f32 v72, v72
    v_exp_f32 v73, v73
    v_exp_f32 v74, v74
    v_exp_f32 v75, v75
    v_exp_f32 v76, v76
    v_exp_f32 v77, v77
    v_exp_f32 v78, v78
    v_exp_f32 v79, v79
    v_pk_add_f32 v[64:65], v[64:65], 1.0 op_sel_hi:[1,0]
    v_pk_add_f32 v[66:67], v[66:67], 1.0 op_sel_hi:[1,0]
    v_pk_add_f32 v[68:69], v[68:69], 1.0 op_sel_hi:[1,0]
    v_pk_add_f32 v[70:71], v[70:71], 1.0 op_sel_hi:[1,0]
    v_pk_add_f32 v[72:73], v[72:73], 1.0 op_sel_hi:[1,0]
    v_pk_add_f32 v[74:75], v[74:75], 1.0 op_sel_hi:[1,0]
    v_pk_add_f32 v[76:77], v[76:77], 1.0 op_sel_hi:[1,0]
    v_pk_add_f32 v[78:79], v[78:79], 1.0 op_sel_hi:[1,0]
    v_rcp_f32 v64, v64
    v_rcp_f32 v65, v65
    v_rcp_f32 v66, v66
    v_rcp_f32 v67, v67
    v_rcp_f32 v68, v68
    v_rcp_f32 v69, v69
    v_rcp_f32 v70, v70
    v_rcp_f32 v71, v71
    v_rcp_f32 v72, v72
    v_rcp_f32 v73, v73
    v_rcp_f32 v74, v74
    v_rcp_f32 v75, v75
    v_rcp_f32 v76, v76
    v_rcp_f32 v77, v77
    v_rcp_f32 v78, v78
    v_rcp_f32 v79, v79
    v_pk_mul_f32 v[192:193], v[192:193], v[208:209]
    v_pk_mul_f32 v[194:195], v[194:195], v[210:211]
    v_pk_mul_f32 v[196:197], v[196:197], v[212:213]
    v_pk_mul_f32 v[198:199], v[198:199], v[214:215]
    v_pk_mul_f32 v[200:201], v[200:201], v[216:217]
    v_pk_mul_f32 v[202:203], v[202:203], v[218:219]
    v_pk_mul_f32 v[204:205], v[204:205], v[220:221]
    v_pk_mul_f32 v[206:207], v[206:207], v[222:223]
    v_pk_mul_f32 v[120:121], v[192:193], v[64:65]
    v_pk_mul_f32 v[122:123], v[194:195], v[66:67]
    v_pk_fma_f32 v[120:121], v[196:197], v[68:69], v[120:121]
    v_pk_fma_f32 v[122:123], v[198:199], v[70:71], v[122:123]
    v_pk_fma_f32 v[120:121], v[200:201], v[72:73], v[120:121]
    v_pk_fma_f32 v[122:123], v[202:203], v[74:75], v[122:123]
    v_pk_fma_f32 v[120:121], v[204:205], v[76:77], v[120:121]
    v_pk_fma_f32 v[122:123], v[206:207], v[78:79], v[122:123]
    v_pk_add_f32 v[120:121], v[120:121], v[122:123]
    v_add_f32 v120, v120, v121
    v_add_f32_dpp v150, v150, v150 row_ror:4 row_mask:0xf bank_mask:0xf
    s_nop 0
    v_add_f32_dpp v120, v120, v120 row_ror:4 row_mask:0xf bank_mask:0xf
    v_add_f32_dpp v150, v150, v150 row_ror:8 row_mask:0xf bank_mask:0xf
    s_nop 0
    v_add_f32_dpp v120, v120, v120 row_ror:8 row_mask:0xf bank_mask:0xf
    v_mov_b32 v151, v150
    v_mov_b32 v121, v120
    s_nop 0
    v_permlane16_swap_b32 v150, v151
    v_permlane16_swap_b32 v120, v121
    v_add_f32 v150, v150, v151
    v_add_f32 v120, v120, v121
    v_mov_b32 v151, v150
    v_mov_b32 v121, v120
    s_nop 0
    v_permlane32_swap_b32 v150, v151
    v_permlane32_swap_b32 v120, v121
    v_add_f32 v150, v150, v151
    v_add_f32 v120, v120, v121
    v_cvt_pk_bf16_f32 v124, v120, v150
    v_and_b32 v150, s79, v124
    v_lshlrev_b32 v124, 16, v124
    v_add_f32 v124, v124, v226
    v_cvt_pk_bf16_f32 v124, v124, v124
    v_lshlrev_b32 v124, 16, v124
    v_add_f32 v124, v124, v150
    v_cvt_pk_bf16_f32 v124, v124, v124
    s_mov_b64 exec, 15
    buffer_store_short v124, v147, s[44:47], s3 offen sc0 sc1
L_end:
s_endpgm
.section .rodata,"a"
.p2align 6
.amdhsa_kernel standalone__deep_cross_pnn__recsys_kernel
  .amdhsa_next_free_vgpr 512
  .amdhsa_next_free_sgpr 102
  .amdhsa_accum_offset 256
  .amdhsa_group_segment_fixed_size 0
  .amdhsa_kernarg_size 80
  .amdhsa_user_sgpr_count 2
  .amdhsa_user_sgpr_kernarg_segment_ptr 1
  .amdhsa_system_sgpr_workgroup_id_x 1
.end_amdhsa_kernel
```
